```python
import torch

def _softmax(x, axis=-1):
    return torch.softmax(x, dim=axis)
def _gelu(x):
    return torch.nn.functional.gelu(x, approximate="tanh")
def _silu(x):
    return torch.nn.functional.silu(x)
def _sigmoid(x):
    return torch.sigmoid(x)
def _layernorm(x, axis=-1, eps=1e-5):
    m = x.mean(dim=axis, keepdim=True)
    v = x.var(dim=axis, keepdim=True, unbiased=False)
    return (x - m) / torch.sqrt(v + eps)
def _scatter_add(tgt, idx, src, axis=0):
    return tgt.clone().index_add_(axis, idx, src)
def _segment_sum(src, seg, n):
    out = torch.zeros((n,) + src.shape[1:], dtype=src.dtype)
    return out.index_add_(0, seg, src)
def _pad(x, pw):
    flat = tuple(v for pair in reversed(pw) for v in pair)
    return torch.nn.functional.pad(x, flat)

kernel_name = 'sequential_preLN__gqa_block_cached__dense_activation_silu__decode'

def setup_inputs():

    _w = (lambda a: (lambda t: t.to(torch.bfloat16) if t.is_floating_point() else t)(torch.as_tensor(a)))
    def _A_setup():
        B, Sq, D = 2, 1, 448
        Hq, Hkv, Sk, Dh = 16, 8, 4096, 256
        assert Hq % Hkv == 0, (Hq, Hkv)
        return {
            "x": _w((lambda *s: torch.randn(*s, dtype=torch.bfloat16) * 0.1)(B, Sq, D)),
            "k_cache": _w((lambda *s: torch.randn(*s, dtype=torch.bfloat16) * 1.6)(B, Hkv, Sk, Dh)),
            "v_cache": _w((lambda *s: torch.randn(*s, dtype=torch.bfloat16) * 1.6)(B, Hkv, Sk, Dh)),
            "wq": _w((lambda *s: torch.randn(*s, dtype=torch.bfloat16) * 1.6)(D, Hq * Dh) * (D ** -0.5)),
            "wo": _w((lambda *s: torch.randn(*s, dtype=torch.bfloat16) * 1.6)(Hq * Dh, D) * ((Hq * Dh) ** -0.5)),
        }
    _A_in = _A_setup()

    def _B_setup():
        B, S, D, F = 2, 1, 448, 1792
        return {
            "x": _w((lambda *s: torch.randn(*s, dtype=torch.bfloat16) * 0.1)(B, S, D)),
            "w1": _w((lambda *s: torch.randn(*s, dtype=torch.bfloat16) * 3.2)(D, F) * (D ** -0.5)),
            "w2": _w((lambda *s: torch.randn(*s, dtype=torch.bfloat16) * 3.2)(F, D) * (F ** -0.5)),
        }
    _B_in = _B_setup()

    return {
        "A_x": _A_in["x"],
        "A_k_cache": _A_in["k_cache"],
        "A_v_cache": _A_in["v_cache"],
        "A_wq": _A_in["wq"],
        "A_wo": _A_in["wo"],
        "B_x": _B_in["x"],
        "B_w1": _B_in["w1"],
        "B_w2": _B_in["w2"],
    }

def reference(A_x, A_k_cache, A_v_cache, A_wq, A_wo, B_x, B_w1, B_w2):
    def _A_ref(x, k_cache, v_cache, wq, wo):
        B, Sq, D = x.shape
        Hq, Dh = 16, 256
        Hkv = k_cache.shape[1]
        rep = Hq // Hkv
        q = (lambda x, *d: x.permute(*d))((x @ wq).reshape(B, Sq, Hq, Dh), 0, 2, 1, 3)
        k = (lambda x, n, axis: torch.repeat_interleave(x, n, dim=axis))(k_cache, rep, axis=1)
        v = (lambda x, n, axis: torch.repeat_interleave(x, n, dim=axis))(v_cache, rep, axis=1)
        scores = torch.einsum("bhqd,bhkd->bhqk", q, k) * (Dh ** -0.5)
        p = _softmax(scores, axis=-1)
        o = torch.einsum("bhqk,bhkd->bhqd", p, v)
        return (lambda x, *d: x.permute(*d))(o, 0, 2, 1, 3).reshape(B, Sq, Hq * Dh) @ wo

    def _B_ref(x, w1, w2):
        h = torch.einsum("bsd,df->bsf", x, w1)
        h = _silu(h)
        out = torch.einsum("bsf,fd->bsd", h, w2)
        return out

    x = A_x
    h = x + _A_ref(_layernorm(x, axis=-1), A_k_cache, A_v_cache, A_wq, A_wo)
    h2 = h + _B_ref(_layernorm(h, axis=-1), B_w1, B_w2)
    return h2
```

```asm
; @launch grid=(256,1,1) block=(768,1,1) lds=52736
.amdgcn_target "amdgcn-amd-amdhsa--gfx950"
.text
.globl sequential_preLN__gqa_block_cached__dense_activation_silu__decode_kernel
.p2align 8
.type sequential_preLN__gqa_block_cached__dense_activation_silu__decode_kernel,@function
sequential_preLN__gqa_block_cached__dense_activation_silu__decode_kernel:
    s_cmp_ge_u32 s2, 256
    s_cbranch_scc1 L_end
    s_load_dwordx16 s[64:79], s[0:1], 0
    s_load_dwordx4 s[80:83], s[0:1], 64
    s_load_dwordx2 s[84:85], s[0:1], 80
    v_lshrrev_b32 v2, 6, v0
    v_and_b32 v1, 63, v0
    v_readfirstlane_b32 s40, v2
    s_lshr_b32 s52, s2, 7
    s_bfe_u32 s53, s2, 0x30004
    s_and_b32 s54, s2, 15
    s_mov_b32 s41, 0
    s_mov_b32 s42, s2
    s_cmp_lt_u32 s2, 56
    s_cselect_b32 s41, 1, s41
    s_sub_u32 s56, s2, 64
    s_cmp_lt_u32 s56, 28
    s_cselect_b32 s41, 2, s41
    s_cselect_b32 s42, s56, s42
    s_sub_u32 s56, s2, 128
    s_cmp_lt_u32 s56, 28
    s_cselect_b32 s41, 3, s41
    s_cselect_b32 s42, s56, s42
    s_mov_b32 s44, 0x22222222
    s_mov_b32 s45, 0x22222222
    s_mov_b32 s46, 0x44444444
    s_mov_b32 s47, 0x44444444
    s_mov_b32 s48, 0x88888888
    s_mov_b32 s49, 0x88888888
    s_mov_b32 s50, 0
    s_mov_b32 s51, -1
    s_mov_b32 s61, 0x3db8aa3b
    s_waitcnt lgkmcnt(0)
    s_mov_b32 s8, s66
    s_mov_b32 s9, s67
    s_mov_b32 s10, 33554432
    s_mov_b32 s11, 0x20000
    s_mov_b32 s12, s68
    s_mov_b32 s13, s69
    s_mov_b32 s14, 33554432
    s_mov_b32 s15, 0x20000
    s_mov_b32 s16, s70
    s_mov_b32 s17, s71
    s_mov_b32 s18, 3670016
    s_mov_b32 s19, 0x20000
    s_cmp_eq_u32 s41, 1
    s_cselect_b32 s20, s72, s76
    s_cselect_b32 s21, s73, s77
    s_mov_b32 s22, 1605632
    s_cselect_b32 s22, 3670016, s22
    s_mov_b32 s23, 0x20000
    s_mov_b32 s24, s78
    s_mov_b32 s25, s79
    s_mov_b32 s26, 1605632
    s_mov_b32 s27, 0x20000
    s_mov_b32 s28, s64
    s_mov_b32 s29, s65
    s_mov_b32 s30, 1792
    s_mov_b32 s31, 0x20000
    s_mov_b32 s32, s84
    s_mov_b32 s33, s85
    s_mov_b32 s34, 268435456
    s_mov_b32 s35, 0x20000
    s_mov_b32 s36, s80
    s_mov_b32 s37, s81
    s_mov_b32 s38, 1792
    s_mov_b32 s39, 0x20000
    v_and_b32 v6, 1, v1
    v_lshlrev_b32 v6, 4, v6
    v_mov_b32 v7, 0xffff
    v_lshlrev_b32 v7, v6, v7
    v_bfe_u32 v6, v1, 1, 2
    v_cmp_eq_u32 vcc, 0, v6
    s_nop 1
    v_cndmask_b32 v2, 0, v7, vcc
    v_cmp_eq_u32 vcc, 1, v6
    s_nop 1
    v_cndmask_b32 v3, 0, v7, vcc
    v_cmp_eq_u32 vcc, 2, v6
    s_nop 1
    v_cndmask_b32 v4, 0, v7, vcc
    v_cmp_eq_u32 vcc, 3, v6
    s_nop 1
    v_cndmask_b32 v5, 0, v7, vcc
    s_mov_b32 s62, s40
    s_mov_b32 s86, s40
    s_sub_u32 s40, s40, 4
    s_cmp_lt_u32 s86, 4
    s_cbranch_scc1 L_helper
    s_lshl_b32 s55, s2, 17
    s_lshl_b32 s56, s40, 14
    s_add_u32 s55, s55, s56
    v_bfe_u32 v6, v1, 2, 2
    v_lshlrev_b32 v6, 9, v6
    v_lshrrev_b32 v8, 4, v1
    v_lshl_add_u32 v6, v8, 6, v6
    v_and_b32 v9, 3, v1
    v_lshl_add_u32 v6, v9, 4, v6
    v_lshlrev_b32 v7, 9, v8
    v_and_b32 v10, 15, v1
    v_lshl_add_u32 v7, v10, 4, v7
    v_bfe_u32 v11, v1, 3, 1
    v_lshlrev_b32 v167, 9, v11
    v_lshl_add_u32 v167, v8, 6, v167
    v_lshl_add_u32 v167, v9, 4, v167
    v_lshlrev_b32 v166, 5, v11
    s_lshl_b32 s56, s40, 2
    v_add_u32 v160, s56, v166
    buffer_load_dwordx4 v[32:35], v6, s[8:11], s55 offen offset:0 nt
    buffer_load_dwordx4 v[36:39], v6, s[8:11], s55 offen offset:256 nt
    buffer_load_dwordx4 v[40:43], v6, s[8:11], s55 offen offset:2048 nt
    s_waitcnt vmcnt(2)
    buffer_load_dwordx4 v[44:47], v6, s[8:11], s55 offen offset:2304 nt
    s_waitcnt vmcnt(2)
    s_add_u32 s59, s55, 4096
    buffer_load_dwordx4 v[48:51], v6, s[8:11], s59 offen offset:0 nt
    s_waitcnt vmcnt(2)
    s_add_u32 s59, s55, 4096
    buffer_load_dwordx4 v[52:55], v6, s[8:11], s59 offen offset:256 nt
    s_waitcnt vmcnt(2)
    s_add_u32 s59, s55, 4096
    buffer_load_dwordx4 v[56:59], v6, s[8:11], s59 offen offset:2048 nt
    s_waitcnt vmcnt(2)
    s_add_u32 s59, s55, 4096
    buffer_load_dwordx4 v[60:63], v6, s[8:11], s59 offen offset:2304 nt
    s_waitcnt vmcnt(2)
    s_add_u32 s59, s55, 8192
    buffer_load_dwordx4 v[64:67], v6, s[8:11], s59 offen offset:0 nt
    s_waitcnt vmcnt(2)
    s_add_u32 s59, s55, 8192
    buffer_load_dwordx4 v[68:71], v6, s[8:11], s59 offen offset:256 nt
    s_waitcnt vmcnt(2)
    s_add_u32 s59, s55, 8192
    buffer_load_dwordx4 v[72:75], v6, s[8:11], s59 offen offset:2048 nt
    s_waitcnt vmcnt(2)
    s_add_u32 s59, s55, 8192
    buffer_load_dwordx4 v[76:79], v6, s[8:11], s59 offen offset:2304 nt
    s_waitcnt vmcnt(2)
    s_add_u32 s59, s55, 12288
    buffer_load_dwordx4 v[80:83], v6, s[8:11], s59 offen offset:0 nt
    s_waitcnt vmcnt(2)
    s_add_u32 s59, s55, 12288
    buffer_load_dwordx4 v[84:87], v6, s[8:11], s59 offen offset:256 nt
    s_waitcnt vmcnt(2)
    s_add_u32 s59, s55, 12288
    buffer_load_dwordx4 v[88:91], v6, s[8:11], s59 offen offset:2048 nt
    s_waitcnt vmcnt(2)
    s_add_u32 s59, s55, 12288
    buffer_load_dwordx4 v[92:95], v6, s[8:11], s59 offen offset:2304 nt
    s_waitcnt vmcnt(2)
    buffer_load_dwordx4 v[96:99], v7, s[12:15], s55 offen offset:0 nt
    s_waitcnt vmcnt(2)
    buffer_load_dwordx4 v[100:103], v7, s[12:15], s55 offen offset:256 nt
    s_waitcnt vmcnt(2)
    buffer_load_dwordx4 v[104:107], v7, s[12:15], s55 offen offset:2048 nt
    s_waitcnt vmcnt(2)
    buffer_load_dwordx4 v[108:111], v7, s[12:15], s55 offen offset:2304 nt
    s_waitcnt vmcnt(2)
    s_add_u32 s59, s55, 4096
    buffer_load_dwordx4 v[112:115], v7, s[12:15], s59 offen offset:0 nt
    s_waitcnt vmcnt(2)
    s_barrier
    ds_read_b128 v[8:11], v167 offset:0
    ds_read_b128 v[12:15], v167 offset:256
    s_waitcnt lgkmcnt(0)
    v_mfma_f32_16x16x32_bf16 v[24:27], v[32:35], v[8:11], 0
    v_mfma_f32_16x16x32_bf16 v[24:27], v[36:39], v[12:15], v[24:27]
    s_add_u32 s59, s55, 4096
    buffer_load_dwordx4 v[116:119], v7, s[12:15], s59 offen offset:256 nt
    v_mfma_f32_16x16x32_bf16 v[28:31], v[40:43], v[8:11], 0
    v_mfma_f32_16x16x32_bf16 v[28:31], v[44:47], v[12:15], v[28:31]
    s_nop 3
    v_cndmask_b32 v16, v24, v25, s[44:45]
    v_cndmask_b32 v16, v16, v26, s[46:47]
    v_cndmask_b32 v16, v16, v27, s[48:49]
    s_nop 1
    v_add_f32_dpp v16, v16, v16 quad_perm:[1,0,3,2] row_mask:0xf bank_mask:0xf
    s_nop 1
    v_add_f32_dpp v16, v16, v16 quad_perm:[2,3,0,1] row_mask:0xf bank_mask:0xf
    v_cvt_pk_bf16_f32 v16, v16, v16
    v_lshlrev_b32 v16, 16, v16
    v_mfma_f32_16x16x32_bf16 v[24:27], v[48:51], v[8:11], 0
    v_mfma_f32_16x16x32_bf16 v[24:27], v[52:55], v[12:15], v[24:27]
    v_cndmask_b32 v17, v28, v29, s[44:45]
    v_cndmask_b32 v17, v17, v30, s[46:47]
    v_cndmask_b32 v17, v17, v31, s[48:49]
    s_nop 1
    v_add_f32_dpp v17, v17, v17 quad_perm:[1,0,3,2] row_mask:0xf bank_mask:0xf
    s_nop 1
    v_add_f32_dpp v17, v17, v17 quad_perm:[2,3,0,1] row_mask:0xf bank_mask:0xf
    v_cvt_pk_bf16_f32 v17, v17, v17
    v_lshlrev_b32 v17, 16, v17
    v_mfma_f32_16x16x32_bf16 v[28:31], v[56:59], v[8:11], 0
    v_mfma_f32_16x16x32_bf16 v[28:31], v[60:63], v[12:15], v[28:31]
    v_cndmask_b32 v18, v24, v25, s[44:45]
    v_cndmask_b32 v18, v18, v26, s[46:47]
    v_cndmask_b32 v18, v18, v27, s[48:49]
    s_nop 1
    v_add_f32_dpp v18, v18, v18 quad_perm:[1,0,3,2] row_mask:0xf bank_mask:0xf
    s_nop 1
    v_add_f32_dpp v18, v18, v18 quad_perm:[2,3,0,1] row_mask:0xf bank_mask:0xf
    v_cvt_pk_bf16_f32 v18, v18, v18
    v_lshlrev_b32 v18, 16, v18
    s_add_u32 s59, s55, 4096
    buffer_load_dwordx4 v[120:123], v7, s[12:15], s59 offen offset:2048 nt
    v_mfma_f32_16x16x32_bf16 v[24:27], v[64:67], v[8:11], 0
    v_mfma_f32_16x16x32_bf16 v[24:27], v[68:71], v[12:15], v[24:27]
    v_cndmask_b32 v19, v28, v29, s[44:45]
    v_cndmask_b32 v19, v19, v30, s[46:47]
    v_cndmask_b32 v19, v19, v31, s[48:49]
    s_nop 1
    v_add_f32_dpp v19, v19, v19 quad_perm:[1,0,3,2] row_mask:0xf bank_mask:0xf
    s_nop 1
    v_add_f32_dpp v19, v19, v19 quad_perm:[2,3,0,1] row_mask:0xf bank_mask:0xf
    v_cvt_pk_bf16_f32 v19, v19, v19
    v_lshlrev_b32 v19, 16, v19
    v_mfma_f32_16x16x32_bf16 v[28:31], v[72:75], v[8:11], 0
    v_mfma_f32_16x16x32_bf16 v[28:31], v[76:79], v[12:15], v[28:31]
    v_cndmask_b32 v20, v24, v25, s[44:45]
    v_cndmask_b32 v20, v20, v26, s[46:47]
    v_cndmask_b32 v20, v20, v27, s[48:49]
    s_nop 1
    v_add_f32_dpp v20, v20, v20 quad_perm:[1,0,3,2] row_mask:0xf bank_mask:0xf
    s_nop 1
    v_add_f32_dpp v20, v20, v20 quad_perm:[2,3,0,1] row_mask:0xf bank_mask:0xf
    v_cvt_pk_bf16_f32 v20, v20, v20
    v_lshlrev_b32 v20, 16, v20
    v_mfma_f32_16x16x32_bf16 v[24:27], v[80:83], v[8:11], 0
    v_mfma_f32_16x16x32_bf16 v[24:27], v[84:87], v[12:15], v[24:27]
    v_cndmask_b32 v21, v28, v29, s[44:45]
    v_cndmask_b32 v21, v21, v30, s[46:47]
    v_cndmask_b32 v21, v21, v31, s[48:49]
    s_nop 1
    v_add_f32_dpp v21, v21, v21 quad_perm:[1,0,3,2] row_mask:0xf bank_mask:0xf
    s_nop 1
    v_add_f32_dpp v21, v21, v21 quad_perm:[2,3,0,1] row_mask:0xf bank_mask:0xf
    v_cvt_pk_bf16_f32 v21, v21, v21
    v_lshlrev_b32 v21, 16, v21
    s_add_u32 s59, s55, 4096
    buffer_load_dwordx4 v[124:127], v7, s[12:15], s59 offen offset:2304 nt
    v_mfma_f32_16x16x32_bf16 v[28:31], v[88:91], v[8:11], 0
    v_mfma_f32_16x16x32_bf16 v[28:31], v[92:95], v[12:15], v[28:31]
    v_cndmask_b32 v22, v24, v25, s[44:45]
    v_cndmask_b32 v22, v22, v26, s[46:47]
    v_cndmask_b32 v22, v22, v27, s[48:49]
    s_nop 1
    v_add_f32_dpp v22, v22, v22 quad_perm:[1,0,3,2] row_mask:0xf bank_mask:0xf
    s_nop 1
    v_add_f32_dpp v22, v22, v22 quad_perm:[2,3,0,1] row_mask:0xf bank_mask:0xf
    v_cvt_pk_bf16_f32 v22, v22, v22
    v_lshlrev_b32 v22, 16, v22
    v_cndmask_b32 v23, v28, v29, s[44:45]
    v_cndmask_b32 v23, v23, v30, s[46:47]
    v_cndmask_b32 v23, v23, v31, s[48:49]
    s_nop 1
    v_add_f32_dpp v23, v23, v23 quad_perm:[1,0,3,2] row_mask:0xf bank_mask:0xf
    s_nop 1
    v_add_f32_dpp v23, v23, v23 quad_perm:[2,3,0,1] row_mask:0xf bank_mask:0xf
    v_cvt_pk_bf16_f32 v23, v23, v23
    v_lshlrev_b32 v23, 16, v23
    v_max3_f32 v161, v16, v17, v18
    v_max3_f32 v161, v161, v19, v20
    v_max3_f32 v161, v161, v21, v22
    v_max_f32 v161, v161, v23
    v_mov_b32 v162, v161
    s_nop 1
    v_permlane16_swap_b32 v161, v162
    v_max_f32 v161, v161, v162
    v_mov_b32 v162, v161
    s_nop 1
    v_permlane32_swap_b32 v161, v162
    v_max_f32 v161, v161, v162
    ds_write_b32 v160, v161 offset:1024
    s_cmp_eq_u32 s41, 1
    s_cbranch_scc1 L_d_role1
    s_cmp_eq_u32 s41, 2
    s_cbranch_scc1 L_d_role2
    v_lshrrev_b32 v163, 4, v1
    v_bfe_u32 v164, v1, 3, 1
    v_and_b32 v165, 7, v1
    s_waitcnt lgkmcnt(0)
    s_barrier
    ds_read_b128 v[24:27], v166 offset:1024
    ds_read_b128 v[28:31], v166 offset:1040
    s_add_u32 s59, s55, 8192
    buffer_load_dwordx4 v[128:131], v7, s[12:15], s59 offen offset:0 nt
    s_waitcnt lgkmcnt(0)
    v_max3_f32 v161, v24, v25, v26
    v_max3_f32 v161, v161, v27, v28
    v_max3_f32 v161, v161, v29, v30
    v_max_f32 v161, v161, v31
    v_mul_f32 v161, s61, v161
    v_fma_f32 v16, v16, s61, -v161
    v_fma_f32 v17, v17, s61, -v161
    v_fma_f32 v18, v18, s61, -v161
    v_fma_f32 v19, v19, s61, -v161
    v_fma_f32 v20, v20, s61, -v161
    v_fma_f32 v21, v21, s61, -v161
    v_fma_f32 v22, v22, s61, -v161
    v_fma_f32 v23, v23, s61, -v161
    v_exp_f32 v16, v16
    v_exp_f32 v17, v17
    v_exp_f32 v18, v18
    v_exp_f32 v19, v19
    v_exp_f32 v20, v20
    v_exp_f32 v21, v21
    v_exp_f32 v22, v22
    v_exp_f32 v23, v23
    v_cvt_pk_bf16_f32 v16, v16, v16
    v_cvt_pk_bf16_f32 v17, v17, v17
    v_cvt_pk_bf16_f32 v18, v18, v18
    v_cvt_pk_bf16_f32 v19, v19, v19
    v_cvt_pk_bf16_f32 v20, v20, v20
    v_cvt_pk_bf16_f32 v21, v21, v21
    v_cvt_pk_bf16_f32 v22, v22, v22
    v_cvt_pk_bf16_f32 v23, v23, v23
    v_and_b32 v162, 0xffff0000, v16
    v_and_b32 v24, 0xffff0000, v17
    v_add_f32 v162, v162, v24
    v_and_b32 v24, 0xffff0000, v18
    v_add_f32 v162, v162, v24
    v_and_b32 v24, 0xffff0000, v19
    v_add_f32 v162, v162, v24
    v_and_b32 v24, 0xffff0000, v20
    v_add_f32 v162, v162, v24
    v_and_b32 v24, 0xffff0000, v21
    v_add_f32 v162, v162, v24
    v_and_b32 v24, 0xffff0000, v22
    v_add_f32 v162, v162, v24
    v_and_b32 v24, 0xffff0000, v23
    v_add_f32 v162, v162, v24
    v_mov_b32 v24, v162
    s_nop 1
    v_permlane16_swap_b32 v162, v24
    v_add_f32 v162, v162, v24
    v_mov_b32 v24, v162
    s_nop 1
    v_permlane32_swap_b32 v162, v24
    v_add_f32 v162, v162, v24
    ds_write_b32 v160, v162 offset:1088
    s_waitcnt lgkmcnt(0)
    s_barrier
    v_and_b32 v24, v16, v2
    v_and_b32 v25, v16, v3
    v_and_b32 v26, v16, v4
    v_and_b32 v27, v16, v5
    s_waitcnt vmcnt(7)
    s_nop 0
    v_mfma_f32_16x16x32_bf16 v[8:11], v[96:99], v[24:27], 0
    v_mfma_f32_16x16x32_bf16 v[12:15], v[100:103], v[24:27], 0
    v_and_b32 v28, v17, v2
    v_and_b32 v29, v17, v3
    v_and_b32 v30, v17, v4
    v_and_b32 v31, v17, v5
    s_waitcnt vmcnt(5)
    s_nop 0
    v_mfma_f32_16x16x32_bf16 v[8:11], v[104:107], v[28:31], v[8:11]
    v_mfma_f32_16x16x32_bf16 v[12:15], v[108:111], v[28:31], v[12:15]
    v_and_b32 v24, v18, v2
    v_and_b32 v25, v18, v3
    v_and_b32 v26, v18, v4
    v_and_b32 v27, v18, v5
    s_waitcnt vmcnt(3)
    s_nop 0
    v_mfma_f32_16x16x32_bf16 v[8:11], v[112:115], v[24:27], v[8:11]
    v_mfma_f32_16x16x32_bf16 v[12:15], v[116:119], v[24:27], v[12:15]
    s_add_u32 s59, s55, 8192
    buffer_load_dwordx4 v[132:135], v7, s[12:15], s59 offen offset:256 nt
    v_and_b32 v28, v19, v2
    v_and_b32 v29, v19, v3
    v_and_b32 v30, v19, v4
    v_and_b32 v31, v19, v5
    s_waitcnt vmcnt(2)
    s_nop 0
    v_mfma_f32_16x16x32_bf16 v[8:11], v[120:123], v[28:31], v[8:11]
    v_mfma_f32_16x16x32_bf16 v[12:15], v[124:127], v[28:31], v[12:15]
    s_add_u32 s59, s55, 8192
    buffer_load_dwordx4 v[136:139], v7, s[12:15], s59 offen offset:2048 nt
    s_add_u32 s59, s55, 8192
    buffer_load_dwordx4 v[140:143], v7, s[12:15], s59 offen offset:2304 nt
    v_and_b32 v24, v20, v2
    v_and_b32 v25, v20, v3
    v_and_b32 v26, v20, v4
    v_and_b32 v27, v20, v5
    s_waitcnt vmcnt(2)
    s_nop 0
    v_mfma_f32_16x16x32_bf16 v[8:11], v[128:131], v[24:27], v[8:11]
    v_mfma_f32_16x16x32_bf16 v[12:15], v[132:135], v[24:27], v[12:15]
    s_add_u32 s59, s55, 12288
    buffer_load_dwordx4 v[144:147], v7, s[12:15], s59 offen offset:0 nt
    s_add_u32 s59, s55, 12288
    buffer_load_dwordx4 v[148:151], v7, s[12:15], s59 offen offset:256 nt
    v_and_b32 v28, v21, v2
    v_and_b32 v29, v21, v3
    v_and_b32 v30, v21, v4
    v_and_b32 v31, v21, v5
    s_waitcnt vmcnt(2)
    s_nop 0
    v_mfma_f32_16x16x32_bf16 v[8:11], v[136:139], v[28:31], v[8:11]
    v_mfma_f32_16x16x32_bf16 v[12:15], v[140:143], v[28:31], v[12:15]
    s_add_u32 s59, s55, 12288
    buffer_load_dwordx4 v[152:155], v7, s[12:15], s59 offen offset:2048 nt
    s_add_u32 s59, s55, 12288
    buffer_load_dwordx4 v[156:159], v7, s[12:15], s59 offen offset:2304 nt
    v_and_b32 v24, v22, v2
    v_and_b32 v25, v22, v3
    v_and_b32 v26, v22, v4
    v_and_b32 v27, v22, v5
    s_waitcnt vmcnt(2)
    s_nop 0
    v_mfma_f32_16x16x32_bf16 v[8:11], v[144:147], v[24:27], v[8:11]
    v_mfma_f32_16x16x32_bf16 v[12:15], v[148:151], v[24:27], v[12:15]
    v_and_b32 v28, v23, v2
    v_and_b32 v29, v23, v3
    v_and_b32 v30, v23, v4
    v_and_b32 v31, v23, v5
    s_waitcnt vmcnt(0)
    s_nop 0
    v_mfma_f32_16x16x32_bf16 v[8:11], v[152:155], v[28:31], v[8:11]
    v_mfma_f32_16x16x32_bf16 v[12:15], v[156:159], v[28:31], v[12:15]
    s_lshl_b32 s56, s40, 11
    v_lshlrev_b32 v6, 4, v1
    v_add_u32 v6, s56, v6
    s_nop 3
    ds_write_b128 v6, v[8:11] offset:18432
    ds_write_b128 v6, v[12:15] offset:19456
    s_waitcnt lgkmcnt(0)
    s_barrier
    s_endpgm
L_d_role1:
    s_nop 7
    v_lshrrev_b32 v163, 4, v1
    v_bfe_u32 v164, v1, 3, 1
    v_and_b32 v165, 7, v1
    v_lshl_add_u32 v6, v163, 4, v164
    v_mul_u32_u24 v6, 896, v6
    v_lshl_add_u32 v6, v165, 4, v6
    s_and_b32 s56, s42, 7
    s_lshl_b32 s56, s56, 9
    s_lshl_b32 s57, s40, 6
    s_add_u32 s56, s56, s57
    s_mul_i32 s56, s56, 896
    s_lshr_b32 s57, s42, 3
    s_lshl_b32 s57, s57, 7
    s_add_u32 s63, s56, s57
    s_waitcnt lgkmcnt(0)
    s_barrier
    ds_read_b128 v[24:27], v166 offset:1024
    ds_read_b128 v[28:31], v166 offset:1040
    s_add_u32 s59, s55, 8192
    buffer_load_dwordx4 v[128:131], v7, s[12:15], s59 offen offset:0 nt
    s_waitcnt lgkmcnt(0)
    v_max3_f32 v161, v24, v25, v26
    v_max3_f32 v161, v161, v27, v28
    v_max3_f32 v161, v161, v29, v30
    v_max_f32 v161, v161, v31
    v_mul_f32 v161, s61, v161
    v_fma_f32 v16, v16, s61, -v161
    v_fma_f32 v17, v17, s61, -v161
    v_fma_f32 v18, v18, s61, -v161
    v_fma_f32 v19, v19, s61, -v161
    v_fma_f32 v20, v20, s61, -v161
    v_fma_f32 v21, v21, s61, -v161
    v_fma_f32 v22, v22, s61, -v161
    v_fma_f32 v23, v23, s61, -v161
    v_exp_f32 v16, v16
    v_exp_f32 v17, v17
    v_exp_f32 v18, v18
    v_exp_f32 v19, v19
    v_exp_f32 v20, v20
    v_exp_f32 v21, v21
    v_exp_f32 v22, v22
    v_exp_f32 v23, v23
    v_cvt_pk_bf16_f32 v16, v16, v16
    v_cvt_pk_bf16_f32 v17, v17, v17
    v_cvt_pk_bf16_f32 v18, v18, v18
    v_cvt_pk_bf16_f32 v19, v19, v19
    v_cvt_pk_bf16_f32 v20, v20, v20
    v_cvt_pk_bf16_f32 v21, v21, v21
    v_cvt_pk_bf16_f32 v22, v22, v22
    v_cvt_pk_bf16_f32 v23, v23, v23
    v_and_b32 v162, 0xffff0000, v16
    v_and_b32 v24, 0xffff0000, v17
    v_add_f32 v162, v162, v24
    v_and_b32 v24, 0xffff0000, v18
    v_add_f32 v162, v162, v24
    v_and_b32 v24, 0xffff0000, v19
    v_add_f32 v162, v162, v24
    v_and_b32 v24, 0xffff0000, v20
    v_add_f32 v162, v162, v24
    v_and_b32 v24, 0xffff0000, v21
    v_add_f32 v162, v162, v24
    v_and_b32 v24, 0xffff0000, v22
    v_add_f32 v162, v162, v24
    v_and_b32 v24, 0xffff0000, v23
    v_add_f32 v162, v162, v24
    v_mov_b32 v24, v162
    s_nop 1
    v_permlane16_swap_b32 v162, v24
    v_add_f32 v162, v162, v24
    v_mov_b32 v24, v162
    s_nop 1
    v_permlane32_swap_b32 v162, v24
    v_add_f32 v162, v162, v24
    ds_write_b32 v160, v162 offset:1088
    s_waitcnt lgkmcnt(0)
    s_barrier
    v_and_b32 v24, v16, v2
    v_and_b32 v25, v16, v3
    v_and_b32 v26, v16, v4
    v_and_b32 v27, v16, v5
    s_waitcnt vmcnt(7)
    s_nop 0
    v_mfma_f32_16x16x32_bf16 v[8:11], v[96:99], v[24:27], 0
    v_mfma_f32_16x16x32_bf16 v[12:15], v[100:103], v[24:27], 0
    v_and_b32 v28, v17, v2
    v_and_b32 v29, v17, v3
    v_and_b32 v30, v17, v4
    v_and_b32 v31, v17, v5
    s_waitcnt vmcnt(5)
    s_nop 0
    v_mfma_f32_16x16x32_bf16 v[8:11], v[104:107], v[28:31], v[8:11]
    v_mfma_f32_16x16x32_bf16 v[12:15], v[108:111], v[28:31], v[12:15]
    v_and_b32 v24, v18, v2
    v_and_b32 v25, v18, v3
    v_and_b32 v26, v18, v4
    v_and_b32 v27, v18, v5
    s_waitcnt vmcnt(3)
    s_nop 0
    v_mfma_f32_16x16x32_bf16 v[8:11], v[112:115], v[24:27], v[8:11]
    v_mfma_f32_16x16x32_bf16 v[12:15], v[116:119], v[24:27], v[12:15]
    s_add_u32 s59, s55, 8192
    buffer_load_dwordx4 v[132:135], v7, s[12:15], s59 offen offset:256 nt
    v_and_b32 v28, v19, v2
    v_and_b32 v29, v19, v3
    v_and_b32 v30, v19, v4
    v_and_b32 v31, v19, v5
    s_waitcnt vmcnt(2)
    s_nop 0
    v_mfma_f32_16x16x32_bf16 v[8:11], v[120:123], v[28:31], v[8:11]
    v_mfma_f32_16x16x32_bf16 v[12:15], v[124:127], v[28:31], v[12:15]
    s_add_u32 s59, s55, 8192
    buffer_load_dwordx4 v[136:139], v7, s[12:15], s59 offen offset:2048 nt
    s_add_u32 s59, s55, 8192
    buffer_load_dwordx4 v[140:143], v7, s[12:15], s59 offen offset:2304 nt
    v_and_b32 v24, v20, v2
    v_and_b32 v25, v20, v3
    v_and_b32 v26, v20, v4
    v_and_b32 v27, v20, v5
    s_waitcnt vmcnt(2)
    s_nop 0
    v_mfma_f32_16x16x32_bf16 v[8:11], v[128:131], v[24:27], v[8:11]
    v_mfma_f32_16x16x32_bf16 v[12:15], v[132:135], v[24:27], v[12:15]
    s_add_u32 s59, s55, 12288
    buffer_load_dwordx4 v[144:147], v7, s[12:15], s59 offen offset:0 nt
    s_add_u32 s59, s55, 12288
    buffer_load_dwordx4 v[148:151], v7, s[12:15], s59 offen offset:256 nt
    v_and_b32 v28, v21, v2
    v_and_b32 v29, v21, v3
    v_and_b32 v30, v21, v4
    v_and_b32 v31, v21, v5
    s_waitcnt vmcnt(2)
    s_nop 0
    v_mfma_f32_16x16x32_bf16 v[8:11], v[136:139], v[28:31], v[8:11]
    v_mfma_f32_16x16x32_bf16 v[12:15], v[140:143], v[28:31], v[12:15]
    s_add_u32 s59, s55, 12288
    buffer_load_dwordx4 v[152:155], v7, s[12:15], s59 offen offset:2048 nt
    s_add_u32 s59, s55, 12288
    buffer_load_dwordx4 v[156:159], v7, s[12:15], s59 offen offset:2304 nt
    v_and_b32 v24, v22, v2
    v_and_b32 v25, v22, v3
    v_and_b32 v26, v22, v4
    v_and_b32 v27, v22, v5
    s_waitcnt vmcnt(2)
    s_nop 0
    v_mfma_f32_16x16x32_bf16 v[8:11], v[144:147], v[24:27], v[8:11]
    v_mfma_f32_16x16x32_bf16 v[12:15], v[148:151], v[24:27], v[12:15]
    buffer_load_dwordx4 v[32:35], v6, s[20:23], s63 offen offset:0 nt
    buffer_load_dwordx4 v[36:39], v6, s[20:23], s63 offen offset:1792 nt
    v_and_b32 v28, v23, v2
    v_and_b32 v29, v23, v3
    v_and_b32 v30, v23, v4
    v_and_b32 v31, v23, v5
    s_waitcnt vmcnt(2)
    s_nop 0
    v_mfma_f32_16x16x32_bf16 v[8:11], v[152:155], v[28:31], v[8:11]
    v_mfma_f32_16x16x32_bf16 v[12:15], v[156:159], v[28:31], v[12:15]
    buffer_load_dwordx4 v[40:43], v6, s[20:23], s63 offen offset:3584 nt
    s_add_u32 s59, s63, 4096
    buffer_load_dwordx4 v[44:47], v6, s[20:23], s59 offen offset:1280 nt
    s_add_u32 s59, s63, 4096
    buffer_load_dwordx4 v[48:51], v6, s[20:23], s59 offen offset:3072 nt
    s_add_u32 s59, s63, 8192
    buffer_load_dwordx4 v[52:55], v6, s[20:23], s59 offen offset:768 nt
    s_add_u32 s59, s63, 8192
    buffer_load_dwordx4 v[56:59], v6, s[20:23], s59 offen offset:2560 nt
    s_add_u32 s59, s63, 12288
    buffer_load_dwordx4 v[60:63], v6, s[20:23], s59 offen offset:256 nt
    s_lshl_b32 s56, s40, 11
    v_lshlrev_b32 v6, 4, v1
    v_add_u32 v6, s56, v6
    ds_write_b128 v6, v[8:11] offset:18432
    ds_write_b128 v6, v[12:15] offset:19456
    s_waitcnt lgkmcnt(0)
    s_barrier
    s_lshl_b32 s56, s40, 10
    v_lshlrev_b32 v6, 4, v1
    v_add_u32 v6, s56, v6
    v_lshlrev_b32 v7, 11, v164
    v_lshl_add_u32 v7, v163, 6, v7
    s_lshl_b32 s56, s40, 8
    v_add_u32 v7, s56, v7
    s_barrier
    ds_read_b128 v[96:99], v7 offset:6144
    ds_read_b128 v[100:103], v7 offset:6160
    ds_read_b128 v[104:107], v7 offset:6176
    ds_read_b128 v[108:111], v7 offset:6192
    s_waitcnt vmcnt(0) lgkmcnt(0)
    v_and_b32 v24, v96, v2
    v_and_b32 v25, v96, v3
    v_and_b32 v26, v96, v4
    v_and_b32 v27, v96, v5
    s_nop 1
    v_mfma_f32_16x16x32_bf16 v[8:11], v[32:35], v[24:27], 0
    v_and_b32 v28, v97, v2
    v_and_b32 v29, v97, v3
    v_and_b32 v30, v97, v4
    v_and_b32 v31, v97, v5
    s_nop 1
    v_mfma_f32_16x16x32_bf16 v[12:15], v[32:35], v[28:31], 0
    v_and_b32 v24, v98, v2
    v_and_b32 v25, v98, v3
    v_and_b32 v26, v98, v4
    v_and_b32 v27, v98, v5
    s_nop 1
    v_mfma_f32_16x16x32_bf16 v[8:11], v[36:39], v[24:27], v[8:11]
    v_and_b32 v28, v99, v2
    v_and_b32 v29, v99, v3
    v_and_b32 v30, v99, v4
    v_and_b32 v31, v99, v5
    s_nop 1
    v_mfma_f32_16x16x32_bf16 v[12:15], v[36:39], v[28:31], v[12:15]
    v_and_b32 v24, v100, v2
    v_and_b32 v25, v100, v3
    v_and_b32 v26, v100, v4
    v_and_b32 v27, v100, v5
    s_nop 1
    v_mfma_f32_16x16x32_bf16 v[8:11], v[40:43], v[24:27], v[8:11]
    v_and_b32 v28, v101, v2
    v_and_b32 v29, v101, v3
    v_and_b32 v30, v101, v4
    v_and_b32 v31, v101, v5
    s_nop 1
    v_mfma_f32_16x16x32_bf16 v[12:15], v[40:43], v[28:31], v[12:15]
    v_and_b32 v24, v102, v2
    v_and_b32 v25, v102, v3
    v_and_b32 v26, v102, v4
    v_and_b32 v27, v102, v5
    s_nop 1
    v_mfma_f32_16x16x32_bf16 v[8:11], v[44:47], v[24:27], v[8:11]
    v_and_b32 v28, v103, v2
    v_and_b32 v29, v103, v3
    v_and_b32 v30, v103, v4
    v_and_b32 v31, v103, v5
    s_nop 1
    v_mfma_f32_16x16x32_bf16 v[12:15], v[44:47], v[28:31], v[12:15]
    v_and_b32 v24, v104, v2
    v_and_b32 v25, v104, v3
    v_and_b32 v26, v104, v4
    v_and_b32 v27, v104, v5
    s_nop 1
    v_mfma_f32_16x16x32_bf16 v[8:11], v[48:51], v[24:27], v[8:11]
    v_and_b32 v28, v105, v2
    v_and_b32 v29, v105, v3
    v_and_b32 v30, v105, v4
    v_and_b32 v31, v105, v5
    s_nop 1
    v_mfma_f32_16x16x32_bf16 v[12:15], v[48:51], v[28:31], v[12:15]
    v_and_b32 v24, v106, v2
    v_and_b32 v25, v106, v3
    v_and_b32 v26, v106, v4
    v_and_b32 v27, v106, v5
    s_nop 1
    v_mfma_f32_16x16x32_bf16 v[8:11], v[52:55], v[24:27], v[8:11]
    v_and_b32 v28, v107, v2
    v_and_b32 v29, v107, v3
    v_and_b32 v30, v107, v4
    v_and_b32 v31, v107, v5
    s_nop 1
    v_mfma_f32_16x16x32_bf16 v[12:15], v[52:55], v[28:31], v[12:15]
    v_and_b32 v24, v108, v2
    v_and_b32 v25, v108, v3
    v_and_b32 v26, v108, v4
    v_and_b32 v27, v108, v5
    s_nop 1
    v_mfma_f32_16x16x32_bf16 v[8:11], v[56:59], v[24:27], v[8:11]
    v_and_b32 v28, v109, v2
    v_and_b32 v29, v109, v3
    v_and_b32 v30, v109, v4
    v_and_b32 v31, v109, v5
    s_nop 1
    v_mfma_f32_16x16x32_bf16 v[12:15], v[56:59], v[28:31], v[12:15]
    v_and_b32 v24, v110, v2
    v_and_b32 v25, v110, v3
    v_and_b32 v26, v110, v4
    v_and_b32 v27, v110, v5
    s_nop 1
    v_mfma_f32_16x16x32_bf16 v[8:11], v[60:63], v[24:27], v[8:11]
    v_and_b32 v28, v111, v2
    v_and_b32 v29, v111, v3
    v_and_b32 v30, v111, v4
    v_and_b32 v31, v111, v5
    s_nop 1
    v_mfma_f32_16x16x32_bf16 v[12:15], v[60:63], v[28:31], v[12:15]
    s_nop 7
    v_cndmask_b32 v16, v8, v12, s[50:51]
    v_cndmask_b32 v17, v9, v13, s[50:51]
    v_cndmask_b32 v18, v10, v14, s[50:51]
    v_cndmask_b32 v19, v11, v15, s[50:51]
    ds_write_b128 v6, v[16:19] offset:10240
    s_waitcnt lgkmcnt(0)
    s_barrier
    s_endpgm
L_d_role2:
    s_nop 7
    v_lshrrev_b32 v163, 4, v1
    v_bfe_u32 v164, v1, 3, 1
    v_and_b32 v165, 7, v1
    v_mul_u32_u24 v6, 14, v163
    v_add_u32 v6, v6, v164
    v_mul_u32_u24 v6, 3584, v6
    v_lshl_add_u32 v6, v165, 4, v6
    s_mul_i32 s56, s40, 200704
    s_lshl_b32 s57, s42, 7
    s_add_u32 s63, s56, s57
    v_and_b32 v162, 15, v1
    v_mul_u32_u24 v167, 14336, v163
    v_lshl_add_u32 v167, v162, 4, v167
    s_cmp_eq_u32 s40, 7
    s_cselect_b32 s57, 3, s40
    s_lshl_b32 s57, s57, 8
    s_mul_i32 s56, s42, 57344
    s_add_u32 s43, s56, s57
    s_waitcnt lgkmcnt(0)
    s_barrier
    ds_read_b128 v[24:27], v166 offset:1024
    ds_read_b128 v[28:31], v166 offset:1040
    s_add_u32 s59, s55, 8192
    buffer_load_dwordx4 v[128:131], v7, s[12:15], s59 offen offset:0 nt
    s_waitcnt lgkmcnt(0)
    v_max3_f32 v161, v24, v25, v26
    v_max3_f32 v161, v161, v27, v28
    v_max3_f32 v161, v161, v29, v30
    v_max_f32 v161, v161, v31
    v_mul_f32 v161, s61, v161
    v_fma_f32 v16, v16, s61, -v161
    v_fma_f32 v17, v17, s61, -v161
    v_fma_f32 v18, v18, s61, -v161
    v_fma_f32 v19, v19, s61, -v161
    v_fma_f32 v20, v20, s61, -v161
    v_fma_f32 v21, v21, s61, -v161
    v_fma_f32 v22, v22, s61, -v161
    v_fma_f32 v23, v23, s61, -v161
    v_exp_f32 v16, v16
    v_exp_f32 v17, v17
    v_exp_f32 v18, v18
    v_exp_f32 v19, v19
    v_exp_f32 v20, v20
    v_exp_f32 v21, v21
    v_exp_f32 v22, v22
    v_exp_f32 v23, v23
    v_cvt_pk_bf16_f32 v16, v16, v16
    v_cvt_pk_bf16_f32 v17, v17, v17
    v_cvt_pk_bf16_f32 v18, v18, v18
    v_cvt_pk_bf16_f32 v19, v19, v19
    v_cvt_pk_bf16_f32 v20, v20, v20
    v_cvt_pk_bf16_f32 v21, v21, v21
    v_cvt_pk_bf16_f32 v22, v22, v22
    v_cvt_pk_bf16_f32 v23, v23, v23
    v_and_b32 v162, 0xffff0000, v16
    v_and_b32 v24, 0xffff0000, v17
    v_add_f32 v162, v162, v24
    v_and_b32 v24, 0xffff0000, v18
    v_add_f32 v162, v162, v24
    v_and_b32 v24, 0xffff0000, v19
    v_add_f32 v162, v162, v24
    v_and_b32 v24, 0xffff0000, v20
    v_add_f32 v162, v162, v24
    v_and_b32 v24, 0xffff0000, v21
    v_add_f32 v162, v162, v24
    v_and_b32 v24, 0xffff0000, v22
    v_add_f32 v162, v162, v24
    v_and_b32 v24, 0xffff0000, v23
    v_add_f32 v162, v162, v24
    v_mov_b32 v24, v162
    s_nop 1
    v_permlane16_swap_b32 v162, v24
    v_add_f32 v162, v162, v24
    v_mov_b32 v24, v162
    s_nop 1
    v_permlane32_swap_b32 v162, v24
    v_add_f32 v162, v162, v24
    ds_write_b32 v160, v162 offset:1088
    s_waitcnt lgkmcnt(0)
    s_barrier
    v_and_b32 v24, v16, v2
    v_and_b32 v25, v16, v3
    v_and_b32 v26, v16, v4
    v_and_b32 v27, v16, v5
    s_waitcnt vmcnt(7)
    s_nop 0
    v_mfma_f32_16x16x32_bf16 v[8:11], v[96:99], v[24:27], 0
    v_mfma_f32_16x16x32_bf16 v[12:15], v[100:103], v[24:27], 0
    v_and_b32 v28, v17, v2
    v_and_b32 v29, v17, v3
    v_and_b32 v30, v17, v4
    v_and_b32 v31, v17, v5
    s_waitcnt vmcnt(5)
    s_nop 0
    v_mfma_f32_16x16x32_bf16 v[8:11], v[104:107], v[28:31], v[8:11]
    v_mfma_f32_16x16x32_bf16 v[12:15], v[108:111], v[28:31], v[12:15]
    v_and_b32 v24, v18, v2
    v_and_b32 v25, v18, v3
    v_and_b32 v26, v18, v4
    v_and_b32 v27, v18, v5
    s_waitcnt vmcnt(3)
    s_nop 0
    v_mfma_f32_16x16x32_bf16 v[8:11], v[112:115], v[24:27], v[8:11]
    v_mfma_f32_16x16x32_bf16 v[12:15], v[116:119], v[24:27], v[12:15]
    s_add_u32 s59, s55, 8192
    buffer_load_dwordx4 v[132:135], v7, s[12:15], s59 offen offset:256 nt
    v_and_b32 v28, v19, v2
    v_and_b32 v29, v19, v3
    v_and_b32 v30, v19, v4
    v_and_b32 v31, v19, v5
    s_waitcnt vmcnt(2)
    s_nop 0
    v_mfma_f32_16x16x32_bf16 v[8:11], v[120:123], v[28:31], v[8:11]
    v_mfma_f32_16x16x32_bf16 v[12:15], v[124:127], v[28:31], v[12:15]
    s_add_u32 s59, s55, 8192
    buffer_load_dwordx4 v[136:139], v7, s[12:15], s59 offen offset:2048 nt
    s_add_u32 s59, s55, 8192
    buffer_load_dwordx4 v[140:143], v7, s[12:15], s59 offen offset:2304 nt
    v_and_b32 v24, v20, v2
    v_and_b32 v25, v20, v3
    v_and_b32 v26, v20, v4
    v_and_b32 v27, v20, v5
    s_waitcnt vmcnt(2)
    s_nop 0
    v_mfma_f32_16x16x32_bf16 v[8:11], v[128:131], v[24:27], v[8:11]
    v_mfma_f32_16x16x32_bf16 v[12:15], v[132:135], v[24:27], v[12:15]
    s_add_u32 s59, s55, 12288
    buffer_load_dwordx4 v[144:147], v7, s[12:15], s59 offen offset:0 nt
    s_add_u32 s59, s55, 12288
    buffer_load_dwordx4 v[148:151], v7, s[12:15], s59 offen offset:256 nt
    v_and_b32 v28, v21, v2
    v_and_b32 v29, v21, v3
    v_and_b32 v30, v21, v4
    v_and_b32 v31, v21, v5
    s_waitcnt vmcnt(2)
    s_nop 0
    v_mfma_f32_16x16x32_bf16 v[8:11], v[136:139], v[28:31], v[8:11]
    v_mfma_f32_16x16x32_bf16 v[12:15], v[140:143], v[28:31], v[12:15]
    s_add_u32 s59, s55, 12288
    buffer_load_dwordx4 v[152:155], v7, s[12:15], s59 offen offset:2048 nt
    s_add_u32 s59, s55, 12288
    buffer_load_dwordx4 v[156:159], v7, s[12:15], s59 offen offset:2304 nt
    v_and_b32 v24, v22, v2
    v_and_b32 v25, v22, v3
    v_and_b32 v26, v22, v4
    v_and_b32 v27, v22, v5
    s_waitcnt vmcnt(2)
    s_nop 0
    v_mfma_f32_16x16x32_bf16 v[8:11], v[144:147], v[24:27], v[8:11]
    v_mfma_f32_16x16x32_bf16 v[12:15], v[148:151], v[24:27], v[12:15]
    v_and_b32 v28, v23, v2
    v_and_b32 v29, v23, v3
    v_and_b32 v30, v23, v4
    v_and_b32 v31, v23, v5
    s_waitcnt vmcnt(0)
    s_nop 0
    v_mfma_f32_16x16x32_bf16 v[8:11], v[152:155], v[28:31], v[8:11]
    v_mfma_f32_16x16x32_bf16 v[12:15], v[156:159], v[28:31], v[12:15]
    s_lshl_b32 s56, s40, 11
    v_lshlrev_b32 v6, 4, v1
    v_add_u32 v6, s56, v6
    s_nop 3
    ds_write_b128 v6, v[8:11] offset:18432
    ds_write_b128 v6, v[12:15] offset:19456
    s_waitcnt lgkmcnt(0)
    s_barrier
    v_mul_u32_u24 v6, 14, v163
    v_add_u32 v6, v6, v164
    v_mul_u32_u24 v6, 3584, v6
    v_lshl_add_u32 v6, v165, 4, v6
    buffer_load_dwordx4 v[32:35], v6, s[20:23], s63 offen offset:0 nt
    s_add_u32 s59, s63, 4096
    buffer_load_dwordx4 v[36:39], v6, s[20:23], s59 offen offset:3072 nt
    s_add_u32 s59, s63, 12288
    buffer_load_dwordx4 v[40:43], v6, s[20:23], s59 offen offset:2048 nt
    s_add_u32 s59, s63, 20480
    buffer_load_dwordx4 v[44:47], v6, s[20:23], s59 offen offset:1024 nt
    s_add_u32 s59, s63, 28672
    buffer_load_dwordx4 v[48:51], v6, s[20:23], s59 offen offset:0 nt
    s_add_u32 s59, s63, 32768
    buffer_load_dwordx4 v[52:55], v6, s[20:23], s59 offen offset:3072 nt
    s_add_u32 s59, s63, 40960
    buffer_load_dwordx4 v[56:59], v6, s[20:23], s59 offen offset:2048 nt
    buffer_load_dwordx4 v[60:63], v167, s[24:27], s43 offen offset:0 nt
    buffer_load_dwordx4 v[64:67], v167, s[24:27], s43 offen offset:1792 nt
    buffer_load_dwordx4 v[68:71], v167, s[24:27], s43 offen offset:3584 nt
    s_add_u32 s59, s43, 4096
    buffer_load_dwordx4 v[72:75], v167, s[24:27], s59 offen offset:1280 nt
    s_add_u32 s59, s43, 4096
    buffer_load_dwordx4 v[76:79], v167, s[24:27], s59 offen offset:3072 nt
    s_add_u32 s59, s43, 8192
    buffer_load_dwordx4 v[80:83], v167, s[24:27], s59 offen offset:768 nt
    s_add_u32 s59, s43, 8192
    buffer_load_dwordx4 v[84:87], v167, s[24:27], s59 offen offset:2560 nt
    s_add_u32 s59, s43, 12288
    buffer_load_dwordx4 v[88:91], v167, s[24:27], s59 offen offset:256 nt
    s_lshl_b32 s56, s40, 10
    v_lshlrev_b32 v6, 4, v1
    v_add_u32 v6, s56, v6
    v_lshlrev_b32 v7, 11, v164
    v_mul_u32_u24 v167, 56, v163
    v_add_u32 v7, v7, v167
    s_mul_i32 s56, s40, 224
    v_add_u32 v7, s56, v7
    v_lshlrev_b32 v167, 8, v164
    v_lshl_add_u32 v167, v163, 6, v167
    v_mov_b32 v112, 0x3f803f80
    s_waitcnt vmcnt(8)
    v_and_b32 v24, v112, v2
    v_and_b32 v25, v112, v3
    v_and_b32 v26, v112, v4
    v_and_b32 v27, v112, v5
    s_nop 1
    v_mfma_f32_16x16x32_bf16 v[8:11], v[32:35], v[24:27], 0
    v_and_b32 v28, v112, v2
    v_and_b32 v29, v112, v3
    v_and_b32 v30, v112, v4
    v_and_b32 v31, v112, v5
    s_nop 1
    v_mfma_f32_16x16x32_bf16 v[12:15], v[32:35], v[28:31], 0
    v_and_b32 v24, v112, v2
    v_and_b32 v25, v112, v3
    v_and_b32 v26, v112, v4
    v_and_b32 v27, v112, v5
    s_nop 1
    v_mfma_f32_16x16x32_bf16 v[8:11], v[36:39], v[24:27], v[8:11]
    v_and_b32 v28, v112, v2
    v_and_b32 v29, v112, v3
    v_and_b32 v30, v112, v4
    v_and_b32 v31, v112, v5
    s_nop 1
    v_mfma_f32_16x16x32_bf16 v[12:15], v[36:39], v[28:31], v[12:15]
    v_and_b32 v24, v112, v2
    v_and_b32 v25, v112, v3
    v_and_b32 v26, v112, v4
    v_and_b32 v27, v112, v5
    s_nop 1
    v_mfma_f32_16x16x32_bf16 v[8:11], v[40:43], v[24:27], v[8:11]
    v_and_b32 v28, v112, v2
    v_and_b32 v29, v112, v3
    v_and_b32 v30, v112, v4
    v_and_b32 v31, v112, v5
    s_nop 1
    v_mfma_f32_16x16x32_bf16 v[12:15], v[40:43], v[28:31], v[12:15]
    v_and_b32 v24, v112, v2
    v_and_b32 v25, v112, v3
    v_and_b32 v26, v112, v4
    v_and_b32 v27, v112, v5
    s_nop 1
    v_mfma_f32_16x16x32_bf16 v[8:11], v[44:47], v[24:27], v[8:11]
    v_and_b32 v28, v112, v2
    v_and_b32 v29, v112, v3
    v_and_b32 v30, v112, v4
    v_and_b32 v31, v112, v5
    s_nop 1
    v_mfma_f32_16x16x32_bf16 v[12:15], v[44:47], v[28:31], v[12:15]
    v_and_b32 v24, v112, v2
    v_and_b32 v25, v112, v3
    v_and_b32 v26, v112, v4
    v_and_b32 v27, v112, v5
    s_nop 1
    v_mfma_f32_16x16x32_bf16 v[8:11], v[48:51], v[24:27], v[8:11]
    v_and_b32 v28, v112, v2
    v_and_b32 v29, v112, v3
    v_and_b32 v30, v112, v4
    v_and_b32 v31, v112, v5
    s_nop 1
    v_mfma_f32_16x16x32_bf16 v[12:15], v[48:51], v[28:31], v[12:15]
    v_and_b32 v24, v112, v2
    v_and_b32 v25, v112, v3
    v_and_b32 v26, v112, v4
    v_and_b32 v27, v112, v5
    s_nop 1
    v_mfma_f32_16x16x32_bf16 v[8:11], v[52:55], v[24:27], v[8:11]
    v_and_b32 v28, v112, v2
    v_and_b32 v29, v112, v3
    v_and_b32 v30, v112, v4
    v_and_b32 v31, v112, v5
    s_nop 1
    v_mfma_f32_16x16x32_bf16 v[12:15], v[52:55], v[28:31], v[12:15]
    v_and_b32 v24, v112, v2
    v_and_b32 v25, v112, v3
    v_and_b32 v26, v112, v4
    v_and_b32 v27, v112, v5
    s_nop 1
    v_mfma_f32_16x16x32_bf16 v[8:11], v[56:59], v[24:27], v[8:11]
    v_and_b32 v28, v112, v2
    v_and_b32 v29, v112, v3
    v_and_b32 v30, v112, v4
    v_and_b32 v31, v112, v5
    s_nop 1
    v_mfma_f32_16x16x32_bf16 v[12:15], v[56:59], v[28:31], v[12:15]
    s_nop 7
    v_cndmask_b32 v16, v8, v12, s[50:51]
    v_cndmask_b32 v17, v9, v13, s[50:51]
    v_cndmask_b32 v18, v10, v14, s[50:51]
    v_cndmask_b32 v19, v11, v15, s[50:51]
    ds_write_b128 v6, v[16:19] offset:43520
    s_waitcnt lgkmcnt(0)
    s_barrier
    ds_read_b64 v[96:97], v7 offset:6144
    ds_read_b64 v[98:99], v7 offset:6152
    ds_read_b64 v[100:101], v7 offset:6160
    ds_read_b64 v[102:103], v7 offset:6168
    ds_read_b64 v[104:105], v7 offset:6176
    ds_read_b64 v[106:107], v7 offset:6184
    ds_read_b64 v[108:109], v7 offset:6192
    s_waitcnt lgkmcnt(0)
    v_and_b32 v24, v96, v2
    v_and_b32 v25, v96, v3
    v_and_b32 v26, v96, v4
    v_and_b32 v27, v96, v5
    s_nop 1
    v_mfma_f32_16x16x32_bf16 v[8:11], v[32:35], v[24:27], 0
    v_and_b32 v28, v97, v2
    v_and_b32 v29, v97, v3
    v_and_b32 v30, v97, v4
    v_and_b32 v31, v97, v5
    s_nop 1
    v_mfma_f32_16x16x32_bf16 v[12:15], v[32:35], v[28:31], 0
    v_and_b32 v24, v98, v2
    v_and_b32 v25, v98, v3
    v_and_b32 v26, v98, v4
    v_and_b32 v27, v98, v5
    s_nop 1
    v_mfma_f32_16x16x32_bf16 v[8:11], v[36:39], v[24:27], v[8:11]
    v_and_b32 v28, v99, v2
    v_and_b32 v29, v99, v3
    v_and_b32 v30, v99, v4
    v_and_b32 v31, v99, v5
    s_nop 1
    v_mfma_f32_16x16x32_bf16 v[12:15], v[36:39], v[28:31], v[12:15]
    v_and_b32 v24, v100, v2
    v_and_b32 v25, v100, v3
    v_and_b32 v26, v100, v4
    v_and_b32 v27, v100, v5
    s_nop 1
    v_mfma_f32_16x16x32_bf16 v[8:11], v[40:43], v[24:27], v[8:11]
    v_and_b32 v28, v101, v2
    v_and_b32 v29, v101, v3
    v_and_b32 v30, v101, v4
    v_and_b32 v31, v101, v5
    s_nop 1
    v_mfma_f32_16x16x32_bf16 v[12:15], v[40:43], v[28:31], v[12:15]
    v_and_b32 v24, v102, v2
    v_and_b32 v25, v102, v3
    v_and_b32 v26, v102, v4
    v_and_b32 v27, v102, v5
    s_nop 1
    v_mfma_f32_16x16x32_bf16 v[8:11], v[44:47], v[24:27], v[8:11]
    v_and_b32 v28, v103, v2
    v_and_b32 v29, v103, v3
    v_and_b32 v30, v103, v4
    v_and_b32 v31, v103, v5
    s_nop 1
    v_mfma_f32_16x16x32_bf16 v[12:15], v[44:47], v[28:31], v[12:15]
    v_and_b32 v24, v104, v2
    v_and_b32 v25, v104, v3
    v_and_b32 v26, v104, v4
    v_and_b32 v27, v104, v5
    s_nop 1
    v_mfma_f32_16x16x32_bf16 v[8:11], v[48:51], v[24:27], v[8:11]
    v_and_b32 v28, v105, v2
    v_and_b32 v29, v105, v3
    v_and_b32 v30, v105, v4
    v_and_b32 v31, v105, v5
    s_nop 1
    v_mfma_f32_16x16x32_bf16 v[12:15], v[48:51], v[28:31], v[12:15]
    v_and_b32 v24, v106, v2
    v_and_b32 v25, v106, v3
    v_and_b32 v26, v106, v4
    v_and_b32 v27, v106, v5
    s_nop 1
    v_mfma_f32_16x16x32_bf16 v[8:11], v[52:55], v[24:27], v[8:11]
    v_and_b32 v28, v107, v2
    v_and_b32 v29, v107, v3
    v_and_b32 v30, v107, v4
    v_and_b32 v31, v107, v5
    s_nop 1
    v_mfma_f32_16x16x32_bf16 v[12:15], v[52:55], v[28:31], v[12:15]
    v_and_b32 v24, v108, v2
    v_and_b32 v25, v108, v3
    v_and_b32 v26, v108, v4
    v_and_b32 v27, v108, v5
    s_nop 1
    v_mfma_f32_16x16x32_bf16 v[8:11], v[56:59], v[24:27], v[8:11]
    v_and_b32 v28, v109, v2
    v_and_b32 v29, v109, v3
    v_and_b32 v30, v109, v4
    v_and_b32 v31, v109, v5
    s_nop 1
    v_mfma_f32_16x16x32_bf16 v[12:15], v[56:59], v[28:31], v[12:15]
    s_nop 7
    v_cndmask_b32 v16, v8, v12, s[50:51]
    v_cndmask_b32 v17, v9, v13, s[50:51]
    v_cndmask_b32 v18, v10, v14, s[50:51]
    v_cndmask_b32 v19, v11, v15, s[50:51]
    ds_write_b128 v6, v[16:19] offset:10240
    s_waitcnt lgkmcnt(0)
    s_barrier
    s_barrier
    ds_read_b128 v[96:99], v167 offset:1280
    ds_read_b128 v[100:103], v167 offset:1296
    ds_read_b128 v[104:107], v167 offset:1312
    ds_read_b128 v[108:111], v167 offset:1328
    s_waitcnt vmcnt(0) lgkmcnt(0)
    s_cmp_eq_u32 s40, 7
    s_cselect_b32 s56, 4096, 0
    v_subrev_u32 v6, s56, v6
    s_cmp_gt_u32 s40, 3
    s_cbranch_scc1 L_w2odd_1
    v_and_b32 v24, v96, v2
    v_and_b32 v25, v96, v3
    v_and_b32 v26, v96, v4
    v_and_b32 v27, v96, v5
    s_nop 1
    v_mfma_f32_16x16x32_bf16 v[8:11], v[60:63], v[24:27], 0
    v_and_b32 v28, v98, v2
    v_and_b32 v29, v98, v3
    v_and_b32 v30, v98, v4
    v_and_b32 v31, v98, v5
    s_nop 1
    v_mfma_f32_16x16x32_bf16 v[8:11], v[64:67], v[28:31], v[8:11]
    v_and_b32 v24, v100, v2
    v_and_b32 v25, v100, v3
    v_and_b32 v26, v100, v4
    v_and_b32 v27, v100, v5
    s_nop 1
    v_mfma_f32_16x16x32_bf16 v[8:11], v[68:71], v[24:27], v[8:11]
    v_and_b32 v28, v102, v2
    v_and_b32 v29, v102, v3
    v_and_b32 v30, v102, v4
    v_and_b32 v31, v102, v5
    s_nop 1
    v_mfma_f32_16x16x32_bf16 v[8:11], v[72:75], v[28:31], v[8:11]
    v_and_b32 v24, v104, v2
    v_and_b32 v25, v104, v3
    v_and_b32 v26, v104, v4
    v_and_b32 v27, v104, v5
    s_nop 1
    v_mfma_f32_16x16x32_bf16 v[8:11], v[76:79], v[24:27], v[8:11]
    v_and_b32 v28, v106, v2
    v_and_b32 v29, v106, v3
    v_and_b32 v30, v106, v4
    v_and_b32 v31, v106, v5
    s_nop 1
    v_mfma_f32_16x16x32_bf16 v[8:11], v[80:83], v[28:31], v[8:11]
    v_and_b32 v24, v108, v2
    v_and_b32 v25, v108, v3
    v_and_b32 v26, v108, v4
    v_and_b32 v27, v108, v5
    s_nop 1
    v_mfma_f32_16x16x32_bf16 v[8:11], v[84:87], v[24:27], v[8:11]
    v_and_b32 v28, v110, v2
    v_and_b32 v29, v110, v3
    v_and_b32 v30, v110, v4
    v_and_b32 v31, v110, v5
    s_nop 1
    v_mfma_f32_16x16x32_bf16 v[8:11], v[88:91], v[28:31], v[8:11]
    s_nop 7
    ds_write_b128 v6, v[8:11] offset:34816
    s_branch L_w2end_2
L_w2odd_1:
    s_nop 7
    v_and_b32 v24, v97, v2
    v_and_b32 v25, v97, v3
    v_and_b32 v26, v97, v4
    v_and_b32 v27, v97, v5
    s_nop 1
    v_mfma_f32_16x16x32_bf16 v[12:15], v[60:63], v[24:27], 0
    v_and_b32 v28, v99, v2
    v_and_b32 v29, v99, v3
    v_and_b32 v30, v99, v4
    v_and_b32 v31, v99, v5
    s_nop 1
    v_mfma_f32_16x16x32_bf16 v[12:15], v[64:67], v[28:31], v[12:15]
    v_and_b32 v24, v101, v2
    v_and_b32 v25, v101, v3
    v_and_b32 v26, v101, v4
    v_and_b32 v27, v101, v5
    s_nop 1
    v_mfma_f32_16x16x32_bf16 v[12:15], v[68:71], v[24:27], v[12:15]
    v_and_b32 v28, v103, v2
    v_and_b32 v29, v103, v3
    v_and_b32 v30, v103, v4
    v_and_b32 v31, v103, v5
    s_nop 1
    v_mfma_f32_16x16x32_bf16 v[12:15], v[72:75], v[28:31], v[12:15]
    v_and_b32 v24, v105, v2
    v_and_b32 v25, v105, v3
    v_and_b32 v26, v105, v4
    v_and_b32 v27, v105, v5
    s_nop 1
    v_mfma_f32_16x16x32_bf16 v[12:15], v[76:79], v[24:27], v[12:15]
    v_and_b32 v28, v107, v2
    v_and_b32 v29, v107, v3
    v_and_b32 v30, v107, v4
    v_and_b32 v31, v107, v5
    s_nop 1
    v_mfma_f32_16x16x32_bf16 v[12:15], v[80:83], v[28:31], v[12:15]
    v_and_b32 v24, v109, v2
    v_and_b32 v25, v109, v3
    v_and_b32 v26, v109, v4
    v_and_b32 v27, v109, v5
    s_nop 1
    v_mfma_f32_16x16x32_bf16 v[12:15], v[84:87], v[24:27], v[12:15]
    v_and_b32 v28, v111, v2
    v_and_b32 v29, v111, v3
    v_and_b32 v30, v111, v4
    v_and_b32 v31, v111, v5
    s_nop 1
    v_mfma_f32_16x16x32_bf16 v[12:15], v[88:91], v[28:31], v[12:15]
    s_nop 7
    ds_write_b128 v6, v[12:15] offset:35840
L_w2end_2:
    s_nop 7
    s_waitcnt lgkmcnt(0)
    s_barrier
    s_endpgm
L_helper:
    s_nop 7
    s_setprio 3
    s_add_u32 s40, s62, 8
    v_lshrrev_b32 v163, 4, v1
    v_bfe_u32 v164, v1, 3, 1
    v_and_b32 v165, 7, v1
    v_and_b32 v166, 15, v1
    v_lshlrev_b32 v6, 4, v1
    v_mov_b32 v8, 0x7f000000
    v_cmp_gt_u32 vcc, 1, v1
    s_nop 1
    v_cndmask_b32 v156, v8, v6, vcc
    v_cmp_gt_u32 vcc, 32, v1
    s_nop 1
    v_cndmask_b32 v155, v8, v6, vcc
    s_cmp_eq_u32 s62, 3
    s_cselect_b32 s56, 32, 64
    v_cmp_gt_u32 vcc, s56, v1
    s_nop 1
    v_cndmask_b32 v159, 0, 1.0, vcc
    v_cndmask_b32 v158, v8, v6, vcc
    s_cmp_lg_u32 s41, 2
    s_cbranch_scc1 L_nox_3
    v_mul_u32_u24 v7, 896, v164
    v_lshl_add_u32 v7, v163, 6, v7
    v_lshl_add_u32 v7, v165, 1, v7
    s_lshl_b32 s56, s62, 8
    v_add_u32 v7, s56, v7
    v_cndmask_b32 v7, v8, v7, vcc
    buffer_load_ushort v148, v7, s[28:31], 0 offen offset:0
    buffer_load_ushort v149, v7, s[28:31], 0 offen offset:16
    buffer_load_ushort v150, v7, s[28:31], 0 offen offset:32
    buffer_load_ushort v151, v7, s[28:31], 0 offen offset:48
L_nox_3:
    s_nop 7
    s_cmp_lg_u32 s62, 0
    s_cbranch_scc1 L_h_b1
    v_mov_b32 v12, -1
    v_mov_b32 v13, -1
    v_mov_b32 v14, -1
    v_mov_b32 v15, -1
    v_mov_b32 v16, 0
    v_mov_b32 v17, 0
    v_mov_b32 v18, 0
    v_mov_b32 v19, 0
    s_lshr_b32 s87, s2, 2
    s_lshl_b32 s87, s87, 7
    s_and_b32 s56, s2, 3
    s_lshl_b32 s56, s56, 2
    s_add_u32 s87, s87, s56
    s_add_u32 s87, s87, 1245184
    buffer_store_dword v16, v156, s[32:35], s87 offen sc1
    s_lshl_b32 s56, s2, 11
    s_add_u32 s59, s56, 524288
    buffer_store_dwordx4 v[12:15], v6, s[32:35], s59 offen offset:0 sc1
    s_add_u32 s59, s56, 524288
    buffer_store_dwordx4 v[12:15], v6, s[32:35], s59 offen offset:1024 sc1
    s_lshl_b32 s56, s2, 4
    s_add_u32 s59, s56, 262144
    buffer_store_dwordx4 v[12:15], v156, s[32:35], s59 offen offset:0 sc1
    s_cmp_lg_u32 s41, 1
    s_cbranch_scc1 L_s1_4
    s_and_b32 s56, s42, 7
    s_mul_i32 s56, s56, 3584
    s_lshr_b32 s57, s42, 3
    s_lshl_b32 s57, s57, 9
    s_add_u32 s56, s56, s57
    s_add_u32 s59, s56, 1048576
    buffer_store_dwordx4 v[12:15], v155, s[32:35], s59 offen offset:0 sc1
L_s1_4:
    s_nop 0
    s_cmp_lg_u32 s41, 2
    s_cbranch_scc1 L_s2_5
    s_mul_i32 s56, s42, 3584
    s_add_u32 s59, s56, 1114112
    buffer_store_dwordx4 v[12:15], v6, s[32:35], s59 offen offset:0 sc1
    s_add_u32 s59, s56, 1114112
    buffer_store_dwordx4 v[12:15], v6, s[32:35], s59 offen offset:1024 sc1
    s_add_u32 s59, s56, 1114112
    buffer_store_dwordx4 v[12:15], v6, s[32:35], s59 offen offset:2048 sc1
    s_add_u32 s59, s56, 1114112
    buffer_store_dwordx4 v[12:15], v155, s[32:35], s59 offen offset:3072 sc1
    s_cmp_lg_u32 s42, 0
    s_cbranch_scc1 L_s2_5
    s_mov_b32 s59, 1212416
    buffer_store_dwordx4 v[12:15], v6, s[32:35], s59 offen offset:2048 sc1
    s_mov_b32 s59, 1212416
    buffer_store_dwordx4 v[12:15], v6, s[32:35], s59 offen offset:3072 sc1
    s_mov_b32 s59, 1216512
    buffer_store_dwordx4 v[12:15], v6, s[32:35], s59 offen offset:0 sc1
    s_mov_b32 s59, 1216512
    buffer_store_dwordx4 v[12:15], v155, s[32:35], s59 offen offset:1024 sc1
L_s2_5:
    s_nop 0
    v_mov_b32 v20, 0
    v_mov_b32 v21, 1
    s_and_b32 s56, s2, 15
    s_lshl_b32 s56, s56, 4
    v_mov_b32 v23, s56
    s_cmp_ge_u32 s2, 224
    s_cbranch_scc1 L_noq_6
    s_and_b32 s56, s2, 31
    s_mul_i32 s56, s56, 7
    s_lshr_b32 s57, s2, 5
    s_add_u32 s56, s56, s57
    s_lshl_b32 s63, s56, 10
    buffer_store_dwordx4 v[12:15], v6, s[32:35], s63 offen offset:0 sc1
    v_mov_b32 v8, 0x7f000000
    v_cmp_gt_u32 vcc, 56, v1
    s_nop 1
    v_cndmask_b32 v7, v8, v6, vcc
    v_cndmask_b32 v157, 0, 1.0, vcc
    buffer_load_dwordx4 v[96:99], v7, s[28:31], 0 offen
    buffer_load_dwordx4 v[100:103], v7, s[28:31], 0 offen offset:896
    v_lshlrev_b32 v7, 17, v163
    v_lshl_add_u32 v7, v166, 4, v7
    s_lshr_b32 s56, s2, 5
    s_lshl_b32 s56, s56, 19
    s_and_b32 s57, s2, 31
    s_lshl_b32 s57, s57, 8
    s_add_u32 s56, s56, s57
    buffer_load_dwordx4 v[32:35], v7, s[16:19], s56 offen offset:0 nt
    s_add_u32 s59, s56, 8192
    buffer_load_dwordx4 v[36:39], v7, s[16:19], s59 offen offset:0 nt
    s_add_u32 s59, s56, 16384
    buffer_load_dwordx4 v[40:43], v7, s[16:19], s59 offen offset:0 nt
    s_add_u32 s59, s56, 24576
    buffer_load_dwordx4 v[44:47], v7, s[16:19], s59 offen offset:0 nt
    s_add_u32 s59, s56, 32768
    buffer_load_dwordx4 v[48:51], v7, s[16:19], s59 offen offset:0 nt
    s_add_u32 s59, s56, 40960
    buffer_load_dwordx4 v[52:55], v7, s[16:19], s59 offen offset:0 nt
    s_add_u32 s59, s56, 49152
    buffer_load_dwordx4 v[56:59], v7, s[16:19], s59 offen offset:0 nt
    s_add_u32 s59, s56, 57344
    buffer_load_dwordx4 v[60:63], v7, s[16:19], s59 offen offset:0 nt
    s_add_u32 s59, s56, 65536
    buffer_load_dwordx4 v[64:67], v7, s[16:19], s59 offen offset:0 nt
    s_add_u32 s59, s56, 73728
    buffer_load_dwordx4 v[68:71], v7, s[16:19], s59 offen offset:0 nt
    s_add_u32 s59, s56, 81920
    buffer_load_dwordx4 v[72:75], v7, s[16:19], s59 offen offset:0 nt
    s_add_u32 s59, s56, 90112
    buffer_load_dwordx4 v[76:79], v7, s[16:19], s59 offen offset:0 nt
    s_add_u32 s59, s56, 98304
    buffer_load_dwordx4 v[80:83], v7, s[16:19], s59 offen offset:0 nt
    s_add_u32 s59, s56, 106496
    buffer_load_dwordx4 v[84:87], v7, s[16:19], s59 offen offset:0 nt
    s_add_u32 s59, s56, 114688
    buffer_load_dwordx4 v[88:91], v7, s[16:19], s59 offen offset:0 nt
    s_add_u32 s59, s56, 122880
    buffer_load_dwordx4 v[92:95], v7, s[16:19], s59 offen offset:0 nt
    s_waitcnt vmcnt(18)
    s_mov_b32 exec_lo, 1
    s_mov_b32 exec_hi, 0
    global_atomic_add v22, v23, v21, s[82:83] sc0
    s_mov_b64 exec, -1
    s_waitcnt vmcnt(17)
    v_lshlrev_b32 v104, 16, v96
    v_and_b32 v105, 0xffff0000, v96
    v_lshlrev_b32 v106, 16, v97
    v_and_b32 v107, 0xffff0000, v97
    v_lshlrev_b32 v108, 16, v98
    v_and_b32 v109, 0xffff0000, v98
    v_lshlrev_b32 v110, 16, v99
    v_and_b32 v111, 0xffff0000, v99
    v_add_f32 v120, v104, v105
    v_add_f32 v120, v120, v106
    v_add_f32 v120, v120, v107
    v_add_f32 v120, v120, v108
    v_add_f32 v120, v120, v109
    v_add_f32 v120, v120, v110
    v_add_f32 v120, v120, v111
    v_lshlrev_b32 v112, 16, v100
    v_and_b32 v113, 0xffff0000, v100
    v_lshlrev_b32 v114, 16, v101
    v_and_b32 v115, 0xffff0000, v101
    v_lshlrev_b32 v116, 16, v102
    v_and_b32 v117, 0xffff0000, v102
    v_lshlrev_b32 v118, 16, v103
    v_and_b32 v119, 0xffff0000, v103
    v_add_f32 v122, v112, v113
    v_add_f32 v122, v122, v114
    v_add_f32 v122, v122, v115
    v_add_f32 v122, v122, v116
    v_add_f32 v122, v122, v117
    v_add_f32 v122, v122, v118
    v_add_f32 v122, v122, v119
    v_add_f32_dpp v120, v120, v120 quad_perm:[1,0,3,2] row_mask:0xf bank_mask:0xf
    s_nop 0
    v_add_f32_dpp v122, v122, v122 quad_perm:[1,0,3,2] row_mask:0xf bank_mask:0xf
    v_add_f32_dpp v120, v120, v120 quad_perm:[2,3,0,1] row_mask:0xf bank_mask:0xf
    s_nop 0
    v_add_f32_dpp v122, v122, v122 quad_perm:[2,3,0,1] row_mask:0xf bank_mask:0xf
    v_add_f32_dpp v120, v120, v120 row_half_mirror row_mask:0xf bank_mask:0xf
    s_nop 0
    v_add_f32_dpp v122, v122, v122 row_half_mirror row_mask:0xf bank_mask:0xf
    v_add_f32_dpp v120, v120, v120 row_mirror row_mask:0xf bank_mask:0xf
    s_nop 0
    v_add_f32_dpp v122, v122, v122 row_mirror row_mask:0xf bank_mask:0xf
    v_mov_b32 v12, v120
    s_nop 1
    v_permlane16_swap_b32 v120, v12
    v_add_f32 v120, v120, v12
    v_mov_b32 v13, v122
    s_nop 1
    v_permlane16_swap_b32 v122, v13
    v_add_f32 v122, v122, v13
    v_mov_b32 v12, v120
    s_nop 1
    v_permlane32_swap_b32 v120, v12
    v_add_f32 v120, v120, v12
    v_mov_b32 v13, v122
    s_nop 1
    v_permlane32_swap_b32 v122, v13
    v_add_f32 v122, v122, v13
    v_mul_f32 v120, 0x3b124925, v120
    v_sub_f32 v13, v104, v120
    v_mul_f32 v13, v13, v157
    v_mul_f32 v121, v13, v13
    v_sub_f32 v13, v105, v120
    v_mul_f32 v13, v13, v157
    v_fmac_f32 v121, v13, v13
    v_sub_f32 v13, v106, v120
    v_mul_f32 v13, v13, v157
    v_fmac_f32 v121, v13, v13
    v_sub_f32 v13, v107, v120
    v_mul_f32 v13, v13, v157
    v_fmac_f32 v121, v13, v13
    v_sub_f32 v13, v108, v120
    v_mul_f32 v13, v13, v157
    v_fmac_f32 v121, v13, v13
    v_sub_f32 v13, v109, v120
    v_mul_f32 v13, v13, v157
    v_fmac_f32 v121, v13, v13
    v_sub_f32 v13, v110, v120
    v_mul_f32 v13, v13, v157
    v_fmac_f32 v121, v13, v13
    v_sub_f32 v13, v111, v120
    v_mul_f32 v13, v13, v157
    v_fmac_f32 v121, v13, v13
    v_mul_f32 v122, 0x3b124925, v122
    v_sub_f32 v13, v112, v122
    v_mul_f32 v13, v13, v157
    v_mul_f32 v123, v13, v13
    v_sub_f32 v13, v113, v122
    v_mul_f32 v13, v13, v157
    v_fmac_f32 v123, v13, v13
    v_sub_f32 v13, v114, v122
    v_mul_f32 v13, v13, v157
    v_fmac_f32 v123, v13, v13
    v_sub_f32 v13, v115, v122
    v_mul_f32 v13, v13, v157
    v_fmac_f32 v123, v13, v13
    v_sub_f32 v13, v116, v122
    v_mul_f32 v13, v13, v157
    v_fmac_f32 v123, v13, v13
    v_sub_f32 v13, v117, v122
    v_mul_f32 v13, v13, v157
    v_fmac_f32 v123, v13, v13
    v_sub_f32 v13, v118, v122
    v_mul_f32 v13, v13, v157
    v_fmac_f32 v123, v13, v13
    v_sub_f32 v13, v119, v122
    v_mul_f32 v13, v13, v157
    v_fmac_f32 v123, v13, v13
    v_add_f32_dpp v121, v121, v121 quad_perm:[1,0,3,2] row_mask:0xf bank_mask:0xf
    s_nop 0
    v_add_f32_dpp v123, v123, v123 quad_perm:[1,0,3,2] row_mask:0xf bank_mask:0xf
    v_add_f32_dpp v121, v121, v121 quad_perm:[2,3,0,1] row_mask:0xf bank_mask:0xf
    s_nop 0
    v_add_f32_dpp v123, v123, v123 quad_perm:[2,3,0,1] row_mask:0xf bank_mask:0xf
    v_add_f32_dpp v121, v121, v121 row_half_mirror row_mask:0xf bank_mask:0xf
    s_nop 0
    v_add_f32_dpp v123, v123, v123 row_half_mirror row_mask:0xf bank_mask:0xf
    v_add_f32_dpp v121, v121, v121 row_mirror row_mask:0xf bank_mask:0xf
    s_nop 0
    v_add_f32_dpp v123, v123, v123 row_mirror row_mask:0xf bank_mask:0xf
    v_mov_b32 v12, v121
    s_nop 1
    v_permlane16_swap_b32 v121, v12
    v_add_f32 v121, v121, v12
    v_mov_b32 v13, v123
    s_nop 1
    v_permlane16_swap_b32 v123, v13
    v_add_f32 v123, v123, v13
    v_mov_b32 v12, v121
    s_nop 1
    v_permlane32_swap_b32 v121, v12
    v_add_f32 v121, v121, v12
    v_mov_b32 v13, v123
    s_nop 1
    v_permlane32_swap_b32 v123, v13
    v_add_f32 v123, v123, v13
    v_lshlrev_b32 v7, 5, v1
    v_mul_f32 v121, 0x3b124925, v121
    v_cvt_pk_bf16_f32 v120, v120, v120
    v_lshlrev_b32 v120, 16, v120
    v_cvt_pk_bf16_f32 v121, v121, v121
    v_lshlrev_b32 v121, 16, v121
    v_add_f32 v121, 0x3727c5ac, v121
    v_cvt_pk_bf16_f32 v121, v121, v121
    v_lshlrev_b32 v121, 16, v121
    v_sqrt_f32 v121, v121
    s_nop 0
    v_cvt_pk_bf16_f32 v121, v121, v121
    v_lshlrev_b32 v121, 16, v121
    v_rcp_f32 v121, v121
    v_sub_f32 v104, v104, v120
    v_cvt_pk_bf16_f32 v104, v104, v104
    v_lshlrev_b32 v104, 16, v104
    v_mul_f32 v104, v104, v121
    v_cvt_pk_bf16_f32 v104, v104, v104
    v_sub_f32 v105, v105, v120
    v_cvt_pk_bf16_f32 v105, v105, v105
    v_lshlrev_b32 v105, 16, v105
    v_mul_f32 v105, v105, v121
    v_cvt_pk_bf16_f32 v105, v105, v105
    v_sub_f32 v106, v106, v120
    v_cvt_pk_bf16_f32 v106, v106, v106
    v_lshlrev_b32 v106, 16, v106
    v_mul_f32 v106, v106, v121
    v_cvt_pk_bf16_f32 v106, v106, v106
    v_sub_f32 v107, v107, v120
    v_cvt_pk_bf16_f32 v107, v107, v107
    v_lshlrev_b32 v107, 16, v107
    v_mul_f32 v107, v107, v121
    v_cvt_pk_bf16_f32 v107, v107, v107
    v_sub_f32 v108, v108, v120
    v_cvt_pk_bf16_f32 v108, v108, v108
    v_lshlrev_b32 v108, 16, v108
    v_mul_f32 v108, v108, v121
    v_cvt_pk_bf16_f32 v108, v108, v108
    v_sub_f32 v109, v109, v120
    v_cvt_pk_bf16_f32 v109, v109, v109
    v_lshlrev_b32 v109, 16, v109
    v_mul_f32 v109, v109, v121
    v_cvt_pk_bf16_f32 v109, v109, v109
    v_sub_f32 v110, v110, v120
    v_cvt_pk_bf16_f32 v110, v110, v110
    v_lshlrev_b32 v110, 16, v110
    v_mul_f32 v110, v110, v121
    v_cvt_pk_bf16_f32 v110, v110, v110
    v_sub_f32 v111, v111, v120
    v_cvt_pk_bf16_f32 v111, v111, v111
    v_lshlrev_b32 v111, 16, v111
    v_mul_f32 v111, v111, v121
    v_cvt_pk_bf16_f32 v111, v111, v111
    ds_write_b128 v7, v[104:107] offset:2048
    ds_write_b128 v7, v[108:111] offset:2064
    v_mul_f32 v123, 0x3b124925, v123
    v_cvt_pk_bf16_f32 v122, v122, v122
    v_lshlrev_b32 v122, 16, v122
    v_cvt_pk_bf16_f32 v123, v123, v123
    v_lshlrev_b32 v123, 16, v123
    v_add_f32 v123, 0x3727c5ac, v123
    v_cvt_pk_bf16_f32 v123, v123, v123
    v_lshlrev_b32 v123, 16, v123
    v_sqrt_f32 v123, v123
    s_nop 0
    v_cvt_pk_bf16_f32 v123, v123, v123
    v_lshlrev_b32 v123, 16, v123
    v_rcp_f32 v123, v123
    v_sub_f32 v112, v112, v122
    v_cvt_pk_bf16_f32 v112, v112, v112
    v_lshlrev_b32 v112, 16, v112
    v_mul_f32 v112, v112, v123
    v_cvt_pk_bf16_f32 v112, v112, v112
    v_sub_f32 v113, v113, v122
    v_cvt_pk_bf16_f32 v113, v113, v113
    v_lshlrev_b32 v113, 16, v113
    v_mul_f32 v113, v113, v123
    v_cvt_pk_bf16_f32 v113, v113, v113
    v_sub_f32 v114, v114, v122
    v_cvt_pk_bf16_f32 v114, v114, v114
    v_lshlrev_b32 v114, 16, v114
    v_mul_f32 v114, v114, v123
    v_cvt_pk_bf16_f32 v114, v114, v114
    v_sub_f32 v115, v115, v122
    v_cvt_pk_bf16_f32 v115, v115, v115
    v_lshlrev_b32 v115, 16, v115
    v_mul_f32 v115, v115, v123
    v_cvt_pk_bf16_f32 v115, v115, v115
    v_sub_f32 v116, v116, v122
    v_cvt_pk_bf16_f32 v116, v116, v116
    v_lshlrev_b32 v116, 16, v116
    v_mul_f32 v116, v116, v123
    v_cvt_pk_bf16_f32 v116, v116, v116
    v_sub_f32 v117, v117, v122
    v_cvt_pk_bf16_f32 v117, v117, v117
    v_lshlrev_b32 v117, 16, v117
    v_mul_f32 v117, v117, v123
    v_cvt_pk_bf16_f32 v117, v117, v117
    v_sub_f32 v118, v118, v122
    v_cvt_pk_bf16_f32 v118, v118, v118
    v_lshlrev_b32 v118, 16, v118
    v_mul_f32 v118, v118, v123
    v_cvt_pk_bf16_f32 v118, v118, v118
    v_sub_f32 v119, v119, v122
    v_cvt_pk_bf16_f32 v119, v119, v119
    v_lshlrev_b32 v119, 16, v119
    v_mul_f32 v119, v119, v123
    v_cvt_pk_bf16_f32 v119, v119, v119
    ds_write_b128 v7, v[112:115] offset:4096
    ds_write_b128 v7, v[116:119] offset:4112
    v_lshlrev_b32 v7, 11, v164
    v_lshl_add_u32 v7, v163, 6, v7
    s_lshr_b32 s56, s2, 5
    s_lshl_b32 s56, s56, 8
    v_add_u32 v7, s56, v7
    s_waitcnt lgkmcnt(0)
    ds_read_b128 v[104:107], v7 offset:2048
    ds_read_b128 v[108:111], v7 offset:2064
    ds_read_b128 v[112:115], v7 offset:2080
    ds_read_b128 v[116:119], v7 offset:2096
    s_waitcnt lgkmcnt(0)
    v_and_b32 v24, v104, v2
    v_and_b32 v25, v104, v3
    v_and_b32 v26, v104, v4
    v_and_b32 v27, v104, v5
    s_waitcnt vmcnt(16)
    s_nop 0
    v_mfma_f32_16x16x32_bf16 v[8:11], v[32:35], v[24:27], 0
    v_and_b32 v28, v105, v2
    v_and_b32 v29, v105, v3
    v_and_b32 v30, v105, v4
    v_and_b32 v31, v105, v5
    s_waitcnt vmcnt(15)
    s_nop 0
    v_mfma_f32_16x16x32_bf16 v[8:11], v[36:39], v[28:31], v[8:11]
    v_and_b32 v24, v106, v2
    v_and_b32 v25, v106, v3
    v_and_b32 v26, v106, v4
    v_and_b32 v27, v106, v5
    s_waitcnt vmcnt(14)
    s_nop 0
    v_mfma_f32_16x16x32_bf16 v[8:11], v[40:43], v[24:27], v[8:11]
    v_and_b32 v28, v107, v2
    v_and_b32 v29, v107, v3
    v_and_b32 v30, v107, v4
    v_and_b32 v31, v107, v5
    s_waitcnt vmcnt(13)
    s_nop 0
    v_mfma_f32_16x16x32_bf16 v[8:11], v[44:47], v[28:31], v[8:11]
    v_and_b32 v24, v108, v2
    v_and_b32 v25, v108, v3
    v_and_b32 v26, v108, v4
    v_and_b32 v27, v108, v5
    s_waitcnt vmcnt(12)
    s_nop 0
    v_mfma_f32_16x16x32_bf16 v[8:11], v[48:51], v[24:27], v[8:11]
    v_and_b32 v28, v109, v2
    v_and_b32 v29, v109, v3
    v_and_b32 v30, v109, v4
    v_and_b32 v31, v109, v5
    s_waitcnt vmcnt(11)
    s_nop 0
    v_mfma_f32_16x16x32_bf16 v[8:11], v[52:55], v[28:31], v[8:11]
    v_and_b32 v24, v110, v2
    v_and_b32 v25, v110, v3
    v_and_b32 v26, v110, v4
    v_and_b32 v27, v110, v5
    s_waitcnt vmcnt(10)
    s_nop 0
    v_mfma_f32_16x16x32_bf16 v[8:11], v[56:59], v[24:27], v[8:11]
    v_and_b32 v28, v111, v2
    v_and_b32 v29, v111, v3
    v_and_b32 v30, v111, v4
    v_and_b32 v31, v111, v5
    s_waitcnt vmcnt(9)
    s_nop 0
    v_mfma_f32_16x16x32_bf16 v[8:11], v[60:63], v[28:31], v[8:11]
    v_and_b32 v24, v112, v2
    v_and_b32 v25, v112, v3
    v_and_b32 v26, v112, v4
    v_and_b32 v27, v112, v5
    s_waitcnt vmcnt(8)
    s_nop 0
    v_mfma_f32_16x16x32_bf16 v[8:11], v[64:67], v[24:27], v[8:11]
    v_and_b32 v28, v113, v2
    v_and_b32 v29, v113, v3
    v_and_b32 v30, v113, v4
    v_and_b32 v31, v113, v5
    s_waitcnt vmcnt(7)
    s_nop 0
    v_mfma_f32_16x16x32_bf16 v[8:11], v[68:71], v[28:31], v[8:11]
    v_and_b32 v24, v114, v2
    v_and_b32 v25, v114, v3
    v_and_b32 v26, v114, v4
    v_and_b32 v27, v114, v5
    s_waitcnt vmcnt(6)
    s_nop 0
    v_mfma_f32_16x16x32_bf16 v[8:11], v[72:75], v[24:27], v[8:11]
    v_and_b32 v28, v115, v2
    v_and_b32 v29, v115, v3
    v_and_b32 v30, v115, v4
    v_and_b32 v31, v115, v5
    s_waitcnt vmcnt(5)
    s_nop 0
    v_mfma_f32_16x16x32_bf16 v[8:11], v[76:79], v[28:31], v[8:11]
    v_and_b32 v24, v116, v2
    v_and_b32 v25, v116, v3
    v_and_b32 v26, v116, v4
    v_and_b32 v27, v116, v5
    s_waitcnt vmcnt(4)
    s_nop 0
    v_mfma_f32_16x16x32_bf16 v[8:11], v[80:83], v[24:27], v[8:11]
    v_and_b32 v28, v117, v2
    v_and_b32 v29, v117, v3
    v_and_b32 v30, v117, v4
    v_and_b32 v31, v117, v5
    s_waitcnt vmcnt(3)
    s_nop 0
    v_mfma_f32_16x16x32_bf16 v[8:11], v[84:87], v[28:31], v[8:11]
    v_and_b32 v24, v118, v2
    v_and_b32 v25, v118, v3
    v_and_b32 v26, v118, v4
    v_and_b32 v27, v118, v5
    s_waitcnt vmcnt(2)
    s_nop 0
    v_mfma_f32_16x16x32_bf16 v[8:11], v[88:91], v[24:27], v[8:11]
    v_and_b32 v28, v119, v2
    v_and_b32 v29, v119, v3
    v_and_b32 v30, v119, v4
    v_and_b32 v31, v119, v5
    s_waitcnt vmcnt(1)
    s_nop 0
    v_mfma_f32_16x16x32_bf16 v[8:11], v[92:95], v[28:31], v[8:11]
    s_nop 7
    v_and_b32 v8, -2, v8
    v_and_b32 v9, -2, v9
    v_and_b32 v10, -2, v10
    v_and_b32 v11, -2, v11
    buffer_store_dwordx4 v[8:11], v6, s[32:35], s63 offen offset:0 sc1
    s_waitcnt vmcnt(1)
    s_branch L_noq2_7
L_noq_6:
    s_nop 0
    s_waitcnt vmcnt(0)
    s_mov_b32 exec_lo, 1
    s_mov_b32 exec_hi, 0
    global_atomic_add v22, v23, v21, s[82:83] sc0
    s_mov_b64 exec, -1
    s_waitcnt vmcnt(0)
L_noq2_7:
    s_nop 0
    v_readfirstlane_b32 s56, v22
    s_mov_b32 s60, 0
    s_nop 0
    s_and_b32 s56, s56, 15
    s_cmp_lg_u32 s56, 15
    s_cbranch_scc1 L_cnt_8
    v_mov_b32 v23, 4
    s_mov_b32 exec_lo, 1
    s_mov_b32 exec_hi, 0
    global_atomic_add v22, v23, v21, s[82:83] sc0
    s_mov_b64 exec, -1
    s_waitcnt vmcnt(0)
    v_readfirstlane_b32 s56, v22
    s_nop 1
    s_and_b32 s56, s56, 15
    s_cmp_lg_u32 s56, 15
    s_cbranch_scc1 L_cnt_8
    v_lshlrev_b32 v7, 7, v1
    v_mov_b32 v16, 16
    v_mov_b32 v17, 16
    v_mov_b32 v18, 16
    v_mov_b32 v19, 16
    s_mov_b32 s59, 1245184
    buffer_store_dwordx4 v[16:19], v7, s[32:35], s59 offen sc1
    s_branch L_cntok_9
L_cnt_8:
    s_nop 0
    buffer_load_dword v9, v20, s[32:35], s87 offen sc1
    s_waitcnt vmcnt(0)
    v_readfirstlane_b32 s56, v9
    s_nop 1
    s_cmp_eq_u32 s56, 16
    s_cbranch_scc1 L_cntok_9
    s_sleep 4
    s_add_u32 s60, s60, 1
    s_cmp_lt_u32 s60, 200000
    s_cbranch_scc1 L_cnt_8
L_cntok_9:
    s_nop 1
    v_lshrrev_b32 v16, 5, v1
    v_bfe_u32 v17, v1, 3, 2
    v_mul_u32_u24 v7, 7168, v16
    v_lshl_add_u32 v7, v17, 8, v7
    v_lshl_add_u32 v7, v165, 4, v7
    s_mul_i32 s56, s53, 28672
    s_lshl_b32 s57, s52, 7
    s_add_u32 s56, s56, s57
    v_lshlrev_b32 v18, 8, v16
    v_lshl_add_u32 v18, v17, 6, v18
    v_lshl_add_u32 v18, v165, 1, v18
    s_mov_b32 s60, 0
L_poll_10:
    s_nop 1
    buffer_load_dwordx4 v[32:35], v7, s[32:35], s56 offen offset:0 sc1
    buffer_load_dwordx4 v[36:39], v7, s[32:35], s56 offen offset:1024 sc1
    buffer_load_dwordx4 v[40:43], v7, s[32:35], s56 offen offset:2048 sc1
    buffer_load_dwordx4 v[44:47], v7, s[32:35], s56 offen offset:3072 sc1
    s_add_u32 s59, s56, 4096
    buffer_load_dwordx4 v[48:51], v7, s[32:35], s59 offen offset:0 sc1
    s_add_u32 s59, s56, 4096
    buffer_load_dwordx4 v[52:55], v7, s[32:35], s59 offen offset:1024 sc1
    s_add_u32 s59, s56, 4096
    buffer_load_dwordx4 v[56:59], v7, s[32:35], s59 offen offset:2048 sc1
    s_add_u32 s59, s56, 12288
    buffer_load_dwordx4 v[60:63], v7, s[32:35], s59 offen offset:2048 sc1
    s_add_u32 s59, s56, 12288
    buffer_load_dwordx4 v[64:67], v7, s[32:35], s59 offen offset:3072 sc1
    s_add_u32 s59, s56, 16384
    buffer_load_dwordx4 v[68:71], v7, s[32:35], s59 offen offset:0 sc1
    s_add_u32 s59, s56, 16384
    buffer_load_dwordx4 v[72:75], v7, s[32:35], s59 offen offset:1024 sc1
    s_add_u32 s59, s56, 16384
    buffer_load_dwordx4 v[76:79], v7, s[32:35], s59 offen offset:2048 sc1
    s_add_u32 s59, s56, 16384
    buffer_load_dwordx4 v[80:83], v7, s[32:35], s59 offen offset:3072 sc1
    s_add_u32 s59, s56, 20480
    buffer_load_dwordx4 v[84:87], v7, s[32:35], s59 offen offset:0 sc1
    s_waitcnt vmcnt(0)
    v_pk_add_f32 v[8:9], v[32:33], v[36:37]
    v_pk_add_f32 v[10:11], v[34:35], v[38:39]
    v_pk_add_f32 v[8:9], v[8:9], v[40:41]
    v_pk_add_f32 v[10:11], v[10:11], v[42:43]
    v_pk_add_f32 v[8:9], v[8:9], v[44:45]
    v_pk_add_f32 v[10:11], v[10:11], v[46:47]
    v_pk_add_f32 v[8:9], v[8:9], v[48:49]
    v_pk_add_f32 v[10:11], v[10:11], v[50:51]
    v_pk_add_f32 v[8:9], v[8:9], v[52:53]
    v_pk_add_f32 v[10:11], v[10:11], v[54:55]
    v_pk_add_f32 v[8:9], v[8:9], v[56:57]
    v_pk_add_f32 v[10:11], v[10:11], v[58:59]
    v_pk_add_f32 v[12:13], v[60:61], v[64:65]
    v_pk_add_f32 v[14:15], v[62:63], v[66:67]
    v_pk_add_f32 v[12:13], v[12:13], v[68:69]
    v_pk_add_f32 v[14:15], v[14:15], v[70:71]
    v_pk_add_f32 v[12:13], v[12:13], v[72:73]
    v_pk_add_f32 v[14:15], v[14:15], v[74:75]
    v_pk_add_f32 v[12:13], v[12:13], v[76:77]
    v_pk_add_f32 v[14:15], v[14:15], v[78:79]
    v_pk_add_f32 v[12:13], v[12:13], v[80:81]
    v_pk_add_f32 v[14:15], v[14:15], v[82:83]
    v_pk_add_f32 v[12:13], v[12:13], v[84:85]
    v_pk_add_f32 v[14:15], v[14:15], v[86:87]
    v_add_f32 v19, v8, v9
    v_add_f32 v19, v19, v10
    v_add_f32 v19, v19, v11
    v_add_f32 v19, v19, v12
    v_add_f32 v19, v19, v13
    v_add_f32 v19, v19, v14
    v_add_f32 v19, v19, v15
    v_cmp_u_f32 vcc, v19, v19
    s_cbranch_vccz L_ok_11
    v_or_b32 v19, v32, v33
    v_or3_b32 v19, v19, v34, v35
    v_or3_b32 v19, v19, v36, v37
    v_or3_b32 v19, v19, v38, v39
    v_or3_b32 v19, v19, v40, v41
    v_or3_b32 v19, v19, v42, v43
    v_or3_b32 v19, v19, v44, v45
    v_or3_b32 v19, v19, v46, v47
    v_or3_b32 v19, v19, v48, v49
    v_or3_b32 v19, v19, v50, v51
    v_or3_b32 v19, v19, v52, v53
    v_or3_b32 v19, v19, v54, v55
    v_or3_b32 v19, v19, v56, v57
    v_or3_b32 v19, v19, v58, v59
    v_or3_b32 v19, v19, v60, v61
    v_or3_b32 v19, v19, v62, v63
    v_or3_b32 v19, v19, v64, v65
    v_or3_b32 v19, v19, v66, v67
    v_or3_b32 v19, v19, v68, v69
    v_or3_b32 v19, v19, v70, v71
    v_or3_b32 v19, v19, v72, v73
    v_or3_b32 v19, v19, v74, v75
    v_or3_b32 v19, v19, v76, v77
    v_or3_b32 v19, v19, v78, v79
    v_or3_b32 v19, v19, v80, v81
    v_or3_b32 v19, v19, v82, v83
    v_or3_b32 v19, v19, v84, v85
    v_or3_b32 v19, v19, v86, v87
    v_and_b32 v19, 1, v19
    v_cmp_ne_u32 vcc, 0, v19
    s_cbranch_vccz L_ok_11
    s_add_u32 s60, s60, 1
    s_cmp_lt_u32 s60, 200000
    s_cbranch_scc1 L_poll_10
L_ok_11:
    s_nop 1
    v_cvt_pk_bf16_f32 v8, v8, v8
    ds_write_b16 v18, v8 offset:0
    v_cvt_pk_bf16_f32 v9, v9, v9
    ds_write_b16 v18, v9 offset:16
    v_cvt_pk_bf16_f32 v10, v10, v10
    ds_write_b16 v18, v10 offset:32
    v_cvt_pk_bf16_f32 v11, v11, v11
    ds_write_b16 v18, v11 offset:48
    v_cvt_pk_bf16_f32 v12, v12, v12
    ds_write_b16 v18, v12 offset:512
    v_cvt_pk_bf16_f32 v13, v13, v13
    ds_write_b16 v18, v13 offset:528
    v_cvt_pk_bf16_f32 v14, v14, v14
    ds_write_b16 v18, v14 offset:544
    v_cvt_pk_bf16_f32 v15, v15, v15
    ds_write_b16 v18, v15 offset:560
L_h_b1:
    s_nop 7
    s_waitcnt lgkmcnt(0)
    s_barrier
    s_barrier
    s_barrier
    s_cmp_lg_u32 s62, 0
    s_cbranch_scc1 L_h_b3
    v_mov_b32 v7, 0
    ds_read_b128 v[32:35], v7 offset:1024
    ds_read_b128 v[36:39], v7 offset:1040
    ds_read_b128 v[40:43], v7 offset:1056
    ds_read_b128 v[44:47], v7 offset:1072
    ds_read_b128 v[48:51], v7 offset:1088
    ds_read_b128 v[52:55], v7 offset:1104
    ds_read_b128 v[56:59], v7 offset:1120
    ds_read_b128 v[60:63], v7 offset:1136
    s_waitcnt lgkmcnt(0)
    v_max3_f32 v8, v32, v33, v34
    v_max3_f32 v8, v8, v35, v36
    v_max3_f32 v8, v8, v37, v38
    v_max_f32 v8, v8, v39
    v_mul_f32 v8, s61, v8
    v_add_f32 v9, v48, v49
    v_add_f32 v9, v9, v50
    v_add_f32 v9, v9, v51
    v_add_f32 v9, v9, v52
    v_add_f32 v9, v9, v53
    v_add_f32 v9, v9, v54
    v_add_f32 v9, v9, v55
    v_max3_f32 v10, v40, v41, v42
    v_max3_f32 v10, v10, v43, v44
    v_max3_f32 v10, v10, v45, v46
    v_max_f32 v10, v10, v47
    v_mul_f32 v10, s61, v10
    v_add_f32 v11, v56, v57
    v_add_f32 v11, v11, v58
    v_add_f32 v11, v11, v59
    v_add_f32 v11, v11, v60
    v_add_f32 v11, v11, v61
    v_add_f32 v11, v11, v62
    v_add_f32 v11, v11, v63
    v_and_b32 v8, -2, v8
    v_and_b32 v9, -2, v9
    v_and_b32 v10, -2, v10
    v_and_b32 v11, -2, v11
    s_lshl_b32 s56, s2, 4
    s_add_u32 s59, s56, 262144
    buffer_store_dwordx4 v[8:11], v156, s[32:35], s59 offen offset:0 sc1
    v_lshlrev_b32 v7, 4, v166
    s_lshr_b32 s56, s2, 4
    s_lshl_b32 s56, s56, 8
    s_mov_b32 s60, 0
L_poll_12:
    s_nop 1
    s_add_u32 s59, s56, 262144
    buffer_load_dwordx4 v[32:35], v7, s[32:35], s59 offen offset:0 sc1
    s_waitcnt vmcnt(0)
    v_or_b32 v12, v32, v33
    v_or3_b32 v12, v12, v34, v35
    v_and_b32 v12, 1, v12
    v_cmp_ne_u32 vcc, 0, v12
    s_cbranch_vccz L_ok_13
    s_add_u32 s60, s60, 1
    s_cmp_lt_u32 s60, 200000
    s_cbranch_scc1 L_poll_12
L_ok_13:
    s_nop 1
    v_mov_b32 v36, v32
    s_nop 1
    v_max_f32_dpp v36, v36, v36 quad_perm:[1,0,3,2] row_mask:0xf bank_mask:0xf
    s_nop 1
    v_max_f32_dpp v36, v36, v36 quad_perm:[2,3,0,1] row_mask:0xf bank_mask:0xf
    s_nop 1
    v_max_f32_dpp v36, v36, v36 row_half_mirror row_mask:0xf bank_mask:0xf
    s_nop 1
    v_max_f32_dpp v36, v36, v36 row_mirror row_mask:0xf bank_mask:0xf
    v_sub_f32 v32, v32, v36
    v_exp_f32 v32, v32
    s_nop 0
    v_mul_f32 v33, v33, v32
    s_nop 1
    v_add_f32_dpp v33, v33, v33 quad_perm:[1,0,3,2] row_mask:0xf bank_mask:0xf
    s_nop 1
    v_add_f32_dpp v33, v33, v33 quad_perm:[2,3,0,1] row_mask:0xf bank_mask:0xf
    s_nop 1
    v_add_f32_dpp v33, v33, v33 row_half_mirror row_mask:0xf bank_mask:0xf
    s_nop 1
    v_add_f32_dpp v33, v33, v33 row_mirror row_mask:0xf bank_mask:0xf
    v_rcp_f32 v33, v33
    v_sub_f32 v36, v8, v36
    v_exp_f32 v36, v36
    s_nop 0
    v_mul_f32 v36, v36, v33
    v_mov_b32 v37, v34
    s_nop 1
    v_max_f32_dpp v37, v37, v37 quad_perm:[1,0,3,2] row_mask:0xf bank_mask:0xf
    s_nop 1
    v_max_f32_dpp v37, v37, v37 quad_perm:[2,3,0,1] row_mask:0xf bank_mask:0xf
    s_nop 1
    v_max_f32_dpp v37, v37, v37 row_half_mirror row_mask:0xf bank_mask:0xf
    s_nop 1
    v_max_f32_dpp v37, v37, v37 row_mirror row_mask:0xf bank_mask:0xf
    v_sub_f32 v34, v34, v37
    v_exp_f32 v34, v34
    s_nop 0
    v_mul_f32 v35, v35, v34
    s_nop 1
    v_add_f32_dpp v35, v35, v35 quad_perm:[1,0,3,2] row_mask:0xf bank_mask:0xf
    s_nop 1
    v_add_f32_dpp v35, v35, v35 quad_perm:[2,3,0,1] row_mask:0xf bank_mask:0xf
    s_nop 1
    v_add_f32_dpp v35, v35, v35 row_half_mirror row_mask:0xf bank_mask:0xf
    s_nop 1
    v_add_f32_dpp v35, v35, v35 row_mirror row_mask:0xf bank_mask:0xf
    v_rcp_f32 v35, v35
    v_sub_f32 v37, v10, v37
    v_exp_f32 v37, v37
    s_nop 0
    v_mul_f32 v37, v37, v35
    v_mov_b32 v7, 0
    ds_write_b64 v7, v[36:37] offset:1152
L_h_b3:
    s_nop 7
    s_waitcnt lgkmcnt(0)
    s_barrier
    s_cmp_ge_u32 s62, 2
    s_cbranch_scc1 L_h_pub_done
    s_lshl_b32 s56, s62, 10
    v_add_u32 v7, s56, v6
    ds_read_b128 v[32:35], v7 offset:18432
    ds_read_b128 v[36:39], v7 offset:20480
    ds_read_b128 v[40:43], v7 offset:22528
    ds_read_b128 v[44:47], v7 offset:24576
    ds_read_b128 v[48:51], v7 offset:26624
    ds_read_b128 v[52:55], v7 offset:28672
    ds_read_b128 v[56:59], v7 offset:30720
    ds_read_b128 v[60:63], v7 offset:32768
    v_lshlrev_b32 v12, 2, v164
    ds_read_b32 v12, v12 offset:1152
    s_waitcnt lgkmcnt(7)
    v_pk_add_f32 v[8:9], v[32:33], v[36:37]
    v_pk_add_f32 v[10:11], v[34:35], v[38:39]
    s_waitcnt lgkmcnt(6)
    v_pk_add_f32 v[8:9], v[8:9], v[40:41]
    v_pk_add_f32 v[10:11], v[10:11], v[42:43]
    s_waitcnt lgkmcnt(5)
    v_pk_add_f32 v[8:9], v[8:9], v[44:45]
    v_pk_add_f32 v[10:11], v[10:11], v[46:47]
    s_waitcnt lgkmcnt(4)
    v_pk_add_f32 v[8:9], v[8:9], v[48:49]
    v_pk_add_f32 v[10:11], v[10:11], v[50:51]
    s_waitcnt lgkmcnt(3)
    v_pk_add_f32 v[8:9], v[8:9], v[52:53]
    v_pk_add_f32 v[10:11], v[10:11], v[54:55]
    s_waitcnt lgkmcnt(2)
    v_pk_add_f32 v[8:9], v[8:9], v[56:57]
    v_pk_add_f32 v[10:11], v[10:11], v[58:59]
    s_waitcnt lgkmcnt(1)
    v_pk_add_f32 v[8:9], v[8:9], v[60:61]
    v_pk_add_f32 v[10:11], v[10:11], v[62:63]
    s_waitcnt lgkmcnt(0)
    v_mul_f32 v8, v8, v12
    v_mul_f32 v9, v9, v12
    v_mul_f32 v10, v10, v12
    v_mul_f32 v11, v11, v12
    v_and_b32 v8, -2, v8
    v_and_b32 v9, -2, v9
    v_and_b32 v10, -2, v10
    v_and_b32 v11, -2, v11
    s_lshl_b32 s57, s2, 11
    s_add_u32 s56, s56, s57
    s_add_u32 s59, s56, 524288
    buffer_store_dwordx4 v[8:11], v6, s[32:35], s59 offen offset:0 sc1
L_h_pub_done:
    s_nop 7
    s_cmp_eq_u32 s41, 1
    s_cbranch_scc1 L_h_role1
    s_cmp_eq_u32 s41, 2
    s_cbranch_scc1 L_h_role2
    s_cmp_eq_u32 s41, 3
    s_cbranch_scc1 L_h_role3
L_h_end:
    s_nop 7
    s_endpgm
L_h_role1:
    s_nop 7
    s_lshr_b32 s56, s62, 1
    s_lshl_b32 s56, s56, 3
    s_and_b32 s57, s42, 7
    s_add_u32 s56, s56, s57
    s_lshl_b32 s56, s56, 15
    s_and_b32 s57, s62, 1
    s_lshl_b32 s57, s57, 10
    s_add_u32 s56, s56, s57
    v_lshlrev_b32 v7, 10, v164
    v_lshl_add_u32 v7, v163, 7, v7
    v_lshl_add_u32 v7, v165, 2, v7
    s_lshr_b32 s57, s62, 1
    s_lshl_b32 s57, s57, 11
    s_and_b32 s58, s62, 1
    s_lshl_b32 s58, s58, 9
    s_add_u32 s57, s57, s58
    v_add_u32 v7, s57, v7
    s_mov_b32 s60, 0
L_poll_14:
    s_nop 1
    s_add_u32 s59, s56, 524288
    buffer_load_dwordx4 v[32:35], v6, s[32:35], s59 offen offset:0 sc1
    s_add_u32 s59, s56, 524288
    buffer_load_dwordx4 v[36:39], v6, s[32:35], s59 offen offset:2048 sc1
    s_add_u32 s59, s56, 528384
    buffer_load_dwordx4 v[40:43], v6, s[32:35], s59 offen offset:0 sc1
    s_add_u32 s59, s56, 528384
    buffer_load_dwordx4 v[44:47], v6, s[32:35], s59 offen offset:2048 sc1
    s_add_u32 s59, s56, 532480
    buffer_load_dwordx4 v[48:51], v6, s[32:35], s59 offen offset:0 sc1
    s_add_u32 s59, s56, 532480
    buffer_load_dwordx4 v[52:55], v6, s[32:35], s59 offen offset:2048 sc1
    s_add_u32 s59, s56, 536576
    buffer_load_dwordx4 v[56:59], v6, s[32:35], s59 offen offset:0 sc1
    s_add_u32 s59, s56, 536576
    buffer_load_dwordx4 v[60:63], v6, s[32:35], s59 offen offset:2048 sc1
    s_add_u32 s59, s56, 540672
    buffer_load_dwordx4 v[64:67], v6, s[32:35], s59 offen offset:0 sc1
    s_add_u32 s59, s56, 540672
    buffer_load_dwordx4 v[68:71], v6, s[32:35], s59 offen offset:2048 sc1
    s_add_u32 s59, s56, 544768
    buffer_load_dwordx4 v[72:75], v6, s[32:35], s59 offen offset:0 sc1
    s_add_u32 s59, s56, 544768
    buffer_load_dwordx4 v[76:79], v6, s[32:35], s59 offen offset:2048 sc1
    s_add_u32 s59, s56, 548864
    buffer_load_dwordx4 v[80:83], v6, s[32:35], s59 offen offset:0 sc1
    s_add_u32 s59, s56, 548864
    buffer_load_dwordx4 v[84:87], v6, s[32:35], s59 offen offset:2048 sc1
    s_add_u32 s59, s56, 552960
    buffer_load_dwordx4 v[88:91], v6, s[32:35], s59 offen offset:0 sc1
    s_add_u32 s59, s56, 552960
    buffer_load_dwordx4 v[92:95], v6, s[32:35], s59 offen offset:2048 sc1
    s_waitcnt vmcnt(0)
    v_pk_add_f32 v[8:9], v[32:33], v[36:37]
    v_pk_add_f32 v[10:11], v[34:35], v[38:39]
    v_pk_add_f32 v[8:9], v[8:9], v[40:41]
    v_pk_add_f32 v[10:11], v[10:11], v[42:43]
    v_pk_add_f32 v[8:9], v[8:9], v[44:45]
    v_pk_add_f32 v[10:11], v[10:11], v[46:47]
    v_pk_add_f32 v[8:9], v[8:9], v[48:49]
    v_pk_add_f32 v[10:11], v[10:11], v[50:51]
    v_pk_add_f32 v[8:9], v[8:9], v[52:53]
    v_pk_add_f32 v[10:11], v[10:11], v[54:55]
    v_pk_add_f32 v[8:9], v[8:9], v[56:57]
    v_pk_add_f32 v[10:11], v[10:11], v[58:59]
    v_pk_add_f32 v[8:9], v[8:9], v[60:61]
    v_pk_add_f32 v[10:11], v[10:11], v[62:63]
    v_pk_add_f32 v[8:9], v[8:9], v[64:65]
    v_pk_add_f32 v[10:11], v[10:11], v[66:67]
    v_pk_add_f32 v[8:9], v[8:9], v[68:69]
    v_pk_add_f32 v[10:11], v[10:11], v[70:71]
    v_pk_add_f32 v[8:9], v[8:9], v[72:73]
    v_pk_add_f32 v[10:11], v[10:11], v[74:75]
    v_pk_add_f32 v[8:9], v[8:9], v[76:77]
    v_pk_add_f32 v[10:11], v[10:11], v[78:79]
    v_pk_add_f32 v[8:9], v[8:9], v[80:81]
    v_pk_add_f32 v[10:11], v[10:11], v[82:83]
    v_pk_add_f32 v[8:9], v[8:9], v[84:85]
    v_pk_add_f32 v[10:11], v[10:11], v[86:87]
    v_pk_add_f32 v[8:9], v[8:9], v[88:89]
    v_pk_add_f32 v[10:11], v[10:11], v[90:91]
    v_pk_add_f32 v[8:9], v[8:9], v[92:93]
    v_pk_add_f32 v[10:11], v[10:11], v[94:95]
    v_add_f32 v12, v8, v9
    v_add_f32 v12, v12, v10
    v_add_f32 v12, v12, v11
    v_cmp_u_f32 vcc, v12, v12
    s_cbranch_vccz L_ok_15
    v_or_b32 v12, v32, v33
    v_or3_b32 v12, v12, v34, v35
    v_or3_b32 v12, v12, v36, v37
    v_or3_b32 v12, v12, v38, v39
    v_or3_b32 v12, v12, v40, v41
    v_or3_b32 v12, v12, v42, v43
    v_or3_b32 v12, v12, v44, v45
    v_or3_b32 v12, v12, v46, v47
    v_or3_b32 v12, v12, v48, v49
    v_or3_b32 v12, v12, v50, v51
    v_or3_b32 v12, v12, v52, v53
    v_or3_b32 v12, v12, v54, v55
    v_or3_b32 v12, v12, v56, v57
    v_or3_b32 v12, v12, v58, v59
    v_or3_b32 v12, v12, v60, v61
    v_or3_b32 v12, v12, v62, v63
    v_or3_b32 v12, v12, v64, v65
    v_or3_b32 v12, v12, v66, v67
    v_or3_b32 v12, v12, v68, v69
    v_or3_b32 v12, v12, v70, v71
    v_or3_b32 v12, v12, v72, v73
    v_or3_b32 v12, v12, v74, v75
    v_or3_b32 v12, v12, v76, v77
    v_or3_b32 v12, v12, v78, v79
    v_or3_b32 v12, v12, v80, v81
    v_or3_b32 v12, v12, v82, v83
    v_or3_b32 v12, v12, v84, v85
    v_or3_b32 v12, v12, v86, v87
    v_or3_b32 v12, v12, v88, v89
    v_or3_b32 v12, v12, v90, v91
    v_or3_b32 v12, v12, v92, v93
    v_or3_b32 v12, v12, v94, v95
    v_and_b32 v12, 1, v12
    v_cmp_ne_u32 vcc, 0, v12
    s_cbranch_vccz L_ok_15
    s_add_u32 s60, s60, 1
    s_cmp_lt_u32 s60, 200000
    s_cbranch_scc1 L_poll_14
L_ok_15:
    s_nop 1
    v_cvt_pk_bf16_f32 v8, v8, v8
    ds_write_b32 v7, v8 offset:6144
    v_cvt_pk_bf16_f32 v9, v9, v9
    ds_write_b32 v7, v9 offset:6176
    v_cvt_pk_bf16_f32 v10, v10, v10
    ds_write_b32 v7, v10 offset:6208
    v_cvt_pk_bf16_f32 v11, v11, v11
    ds_write_b32 v7, v11 offset:6240
    s_waitcnt lgkmcnt(0)
    s_barrier
    s_barrier
    s_cmp_lg_u32 s62, 0
    s_cbranch_scc1 L_r1done_16
    v_lshlrev_b32 v6, 4, v1
    ds_read_b128 v[32:35], v6 offset:10240
    ds_read_b128 v[36:39], v6 offset:11264
    ds_read_b128 v[40:43], v6 offset:12288
    ds_read_b128 v[44:47], v6 offset:13312
    ds_read_b128 v[48:51], v6 offset:14336
    ds_read_b128 v[52:55], v6 offset:15360
    ds_read_b128 v[56:59], v6 offset:16384
    ds_read_b128 v[60:63], v6 offset:17408
    s_waitcnt lgkmcnt(6)
    v_pk_add_f32 v[8:9], v[32:33], v[36:37]
    v_pk_add_f32 v[10:11], v[34:35], v[38:39]
    s_waitcnt lgkmcnt(5)
    v_pk_add_f32 v[8:9], v[8:9], v[40:41]
    v_pk_add_f32 v[10:11], v[10:11], v[42:43]
    s_waitcnt lgkmcnt(4)
    v_pk_add_f32 v[8:9], v[8:9], v[44:45]
    v_pk_add_f32 v[10:11], v[10:11], v[46:47]
    s_waitcnt lgkmcnt(3)
    v_pk_add_f32 v[8:9], v[8:9], v[48:49]
    v_pk_add_f32 v[10:11], v[10:11], v[50:51]
    s_waitcnt lgkmcnt(2)
    v_pk_add_f32 v[8:9], v[8:9], v[52:53]
    v_pk_add_f32 v[10:11], v[10:11], v[54:55]
    s_waitcnt lgkmcnt(1)
    v_pk_add_f32 v[8:9], v[8:9], v[56:57]
    v_pk_add_f32 v[10:11], v[10:11], v[58:59]
    s_waitcnt lgkmcnt(0)
    v_pk_add_f32 v[8:9], v[8:9], v[60:61]
    v_pk_add_f32 v[10:11], v[10:11], v[62:63]
    v_mov_b32 v12, v8
    v_mov_b32 v13, v9
    v_mov_b32 v14, v10
    v_mov_b32 v15, v11
    v_permlane32_swap_b32 v8, v12
    v_permlane32_swap_b32 v9, v13
    v_permlane32_swap_b32 v10, v14
    v_permlane32_swap_b32 v11, v15
    v_add_f32 v8, v8, v12
    v_add_f32 v9, v9, v13
    v_add_f32 v10, v10, v14
    v_add_f32 v11, v11, v15
    v_and_b32 v8, -2, v8
    v_and_b32 v9, -2, v9
    v_and_b32 v10, -2, v10
    v_and_b32 v11, -2, v11
    s_and_b32 s56, s42, 7
    s_mul_i32 s56, s56, 3584
    s_lshr_b32 s57, s42, 3
    s_lshl_b32 s57, s57, 9
    s_add_u32 s56, s56, s57
    s_add_u32 s59, s56, 1048576
    buffer_store_dwordx4 v[8:11], v155, s[32:35], s59 offen offset:0 sc1
L_r1done_16:
    s_nop 7
    s_endpgm
L_h_role2:
    s_nop 7
    s_lshl_b32 s56, s62, 10
    s_waitcnt vmcnt(0)
    v_lshlrev_b32 v148, 16, v148
    v_lshlrev_b32 v149, 16, v149
    v_lshlrev_b32 v150, 16, v150
    v_lshlrev_b32 v151, 16, v151
    s_cmp_eq_u32 s62, 3
    s_mov_b32 s58, 0x3c000000
    s_cselect_b32 s58, 0x3c800000, s58
    s_lshl_b32 s57, s62, 3
    v_lshlrev_b32 v7, 5, v164
    v_add_u32 v7, s57, v7
    v_lshlrev_b32 v14, 11, v164
    v_lshl_add_u32 v14, v163, 7, v14
    v_lshl_add_u32 v14, v165, 2, v14
    s_lshl_b32 s57, s62, 9
    v_add_u32 v14, s57, v14
    s_mov_b32 s60, 0
L_poll_17:
    s_nop 1
    s_add_u32 s59, s56, 1048576
    buffer_load_dwordx4 v[32:35], v158, s[32:35], s59 offen offset:0 sc1
    s_add_u32 s59, s56, 1048576
    buffer_load_dwordx4 v[36:39], v158, s[32:35], s59 offen offset:3584 sc1
    s_add_u32 s59, s56, 1052672
    buffer_load_dwordx4 v[40:43], v158, s[32:35], s59 offen offset:3072 sc1
    s_add_u32 s59, s56, 1056768
    buffer_load_dwordx4 v[44:47], v158, s[32:35], s59 offen offset:2560 sc1
    s_add_u32 s59, s56, 1060864
    buffer_load_dwordx4 v[48:51], v158, s[32:35], s59 offen offset:2048 sc1
    s_add_u32 s59, s56, 1064960
    buffer_load_dwordx4 v[52:55], v158, s[32:35], s59 offen offset:1536 sc1
    s_add_u32 s59, s56, 1069056
    buffer_load_dwordx4 v[56:59], v158, s[32:35], s59 offen offset:1024 sc1
    s_add_u32 s59, s56, 1073152
    buffer_load_dwordx4 v[60:63], v158, s[32:35], s59 offen offset:512 sc1
    s_waitcnt vmcnt(0)
    v_pk_add_f32 v[8:9], v[32:33], v[36:37]
    v_pk_add_f32 v[10:11], v[34:35], v[38:39]
    v_pk_add_f32 v[8:9], v[8:9], v[40:41]
    v_pk_add_f32 v[10:11], v[10:11], v[42:43]
    v_pk_add_f32 v[8:9], v[8:9], v[44:45]
    v_pk_add_f32 v[10:11], v[10:11], v[46:47]
    v_pk_add_f32 v[8:9], v[8:9], v[48:49]
    v_pk_add_f32 v[10:11], v[10:11], v[50:51]
    v_pk_add_f32 v[8:9], v[8:9], v[52:53]
    v_pk_add_f32 v[10:11], v[10:11], v[54:55]
    v_pk_add_f32 v[8:9], v[8:9], v[56:57]
    v_pk_add_f32 v[10:11], v[10:11], v[58:59]
    v_pk_add_f32 v[8:9], v[8:9], v[60:61]
    v_pk_add_f32 v[10:11], v[10:11], v[62:63]
    v_add_f32 v12, v8, v9
    v_add_f32 v12, v12, v10
    v_add_f32 v12, v12, v11
    v_cmp_u_f32 vcc, v12, v12
    s_cbranch_vccz L_ok_18
    v_or_b32 v12, v32, v33
    v_or3_b32 v12, v12, v34, v35
    v_or3_b32 v12, v12, v36, v37
    v_or3_b32 v12, v12, v38, v39
    v_or3_b32 v12, v12, v40, v41
    v_or3_b32 v12, v12, v42, v43
    v_or3_b32 v12, v12, v44, v45
    v_or3_b32 v12, v12, v46, v47
    v_or3_b32 v12, v12, v48, v49
    v_or3_b32 v12, v12, v50, v51
    v_or3_b32 v12, v12, v52, v53
    v_or3_b32 v12, v12, v54, v55
    v_or3_b32 v12, v12, v56, v57
    v_or3_b32 v12, v12, v58, v59
    v_or3_b32 v12, v12, v60, v61
    v_or3_b32 v12, v12, v62, v63
    v_and_b32 v12, 1, v12
    v_cmp_ne_u32 vcc, 0, v12
    s_cbranch_vccz L_ok_18
    s_add_u32 s60, s60, 1
    s_cmp_lt_u32 s60, 200000
    s_cbranch_scc1 L_poll_17
L_ok_18:
    s_nop 1
    v_cvt_pk_bf16_f32 v8, v8, v8
    v_lshlrev_b32 v8, 16, v8
    v_add_f32 v8, v8, v148
    v_cvt_pk_bf16_f32 v8, v8, v8
    v_lshlrev_b32 v8, 16, v8
    v_cvt_pk_bf16_f32 v9, v9, v9
    v_lshlrev_b32 v9, 16, v9
    v_add_f32 v9, v9, v149
    v_cvt_pk_bf16_f32 v9, v9, v9
    v_lshlrev_b32 v9, 16, v9
    v_cvt_pk_bf16_f32 v10, v10, v10
    v_lshlrev_b32 v10, 16, v10
    v_add_f32 v10, v10, v150
    v_cvt_pk_bf16_f32 v10, v10, v10
    v_lshlrev_b32 v10, 16, v10
    v_cvt_pk_bf16_f32 v11, v11, v11
    v_lshlrev_b32 v11, 16, v11
    v_add_f32 v11, v11, v151
    v_cvt_pk_bf16_f32 v11, v11, v11
    v_lshlrev_b32 v11, 16, v11
    s_cmp_lg_u32 s42, 0
    s_cbranch_scc1 L_noh_19
    s_add_u32 s59, s56, 1212416
    buffer_store_dwordx4 v[8:11], v158, s[32:35], s59 offen offset:2048 sc1
L_noh_19:
    s_nop 7
    v_cvt_pk_bf16_f32 v20, v8, v8
    ds_write_b32 v14, v20 offset:6144
    v_cvt_pk_bf16_f32 v21, v9, v9
    ds_write_b32 v14, v21 offset:6176
    v_cvt_pk_bf16_f32 v22, v10, v10
    ds_write_b32 v14, v22 offset:6208
    v_cvt_pk_bf16_f32 v23, v11, v11
    ds_write_b32 v14, v23 offset:6240
    s_waitcnt lgkmcnt(0)
    s_barrier
    s_cmp_ge_u32 s62, 2
    s_cbranch_scc1 L_r2b6_20
    s_cmp_eq_u32 s62, 1
    s_cbranch_scc1 L_r2h1_21
    v_lshrrev_b32 v7, 5, v1
    v_lshlrev_b32 v7, 11, v7
    v_and_b32 v12, 31, v1
    v_mul_u32_u24 v12, 56, v12
    v_add_u32 v7, v7, v12
    ds_read_b64 v[32:33], v7 offset:6144
    ds_read_b64 v[34:35], v7 offset:6152
    ds_read_b64 v[36:37], v7 offset:6160
    ds_read_b64 v[38:39], v7 offset:6168
    ds_read_b64 v[40:41], v7 offset:6176
    ds_read_b64 v[42:43], v7 offset:6184
    ds_read_b64 v[44:45], v7 offset:6192
    s_waitcnt lgkmcnt(0)
    v_and_b32 v32, 0xffff0000, v32
    v_and_b32 v33, 0xffff0000, v33
    v_and_b32 v34, 0xffff0000, v34
    v_and_b32 v35, 0xffff0000, v35
    v_and_b32 v36, 0xffff0000, v36
    v_and_b32 v37, 0xffff0000, v37
    v_and_b32 v38, 0xffff0000, v38
    v_and_b32 v39, 0xffff0000, v39
    v_and_b32 v40, 0xffff0000, v40
    v_and_b32 v41, 0xffff0000, v41
    v_and_b32 v42, 0xffff0000, v42
    v_and_b32 v43, 0xffff0000, v43
    v_and_b32 v44, 0xffff0000, v44
    v_and_b32 v45, 0xffff0000, v45
    v_add_f32 v20, v32, v33
    v_add_f32 v21, v34, v35
    v_add_f32 v20, v20, v36
    v_add_f32 v21, v21, v37
    v_add_f32 v20, v20, v38
    v_add_f32 v21, v21, v39
    v_add_f32 v20, v20, v40
    v_add_f32 v21, v21, v41
    v_add_f32 v20, v20, v42
    v_add_f32 v21, v21, v43
    v_add_f32 v20, v20, v44
    v_add_f32 v21, v21, v45
    v_add_f32 v20, v20, v21
    s_nop 1
    v_add_f32_dpp v20, v20, v20 quad_perm:[1,0,3,2] row_mask:0xf bank_mask:0xf
    s_nop 1
    v_add_f32_dpp v20, v20, v20 quad_perm:[2,3,0,1] row_mask:0xf bank_mask:0xf
    s_nop 1
    v_add_f32_dpp v20, v20, v20 row_half_mirror row_mask:0xf bank_mask:0xf
    s_nop 1
    v_add_f32_dpp v20, v20, v20 row_mirror row_mask:0xf bank_mask:0xf
    v_mov_b32 v12, v20
    s_nop 1
    v_permlane16_swap_b32 v20, v12
    v_add_f32 v20, v20, v12
    v_mul_f32 v20, 0x3b124925, v20
    v_sub_f32 v32, v32, v20
    v_sub_f32 v33, v33, v20
    v_sub_f32 v34, v34, v20
    v_sub_f32 v35, v35, v20
    v_sub_f32 v36, v36, v20
    v_sub_f32 v37, v37, v20
    v_sub_f32 v38, v38, v20
    v_sub_f32 v39, v39, v20
    v_sub_f32 v40, v40, v20
    v_sub_f32 v41, v41, v20
    v_sub_f32 v42, v42, v20
    v_sub_f32 v43, v43, v20
    v_sub_f32 v44, v44, v20
    v_sub_f32 v45, v45, v20
    v_mul_f32 v21, v32, v32
    v_mul_f32 v18, v33, v33
    v_fmac_f32 v21, v34, v34
    v_fmac_f32 v18, v35, v35
    v_fmac_f32 v21, v36, v36
    v_fmac_f32 v18, v37, v37
    v_fmac_f32 v21, v38, v38
    v_fmac_f32 v18, v39, v39
    v_fmac_f32 v21, v40, v40
    v_fmac_f32 v18, v41, v41
    v_fmac_f32 v21, v42, v42
    v_fmac_f32 v18, v43, v43
    v_fmac_f32 v21, v44, v44
    v_fmac_f32 v18, v45, v45
    v_add_f32 v21, v21, v18
    s_nop 1
    v_add_f32_dpp v21, v21, v21 quad_perm:[1,0,3,2] row_mask:0xf bank_mask:0xf
    s_nop 1
    v_add_f32_dpp v21, v21, v21 quad_perm:[2,3,0,1] row_mask:0xf bank_mask:0xf
    s_nop 1
    v_add_f32_dpp v21, v21, v21 row_half_mirror row_mask:0xf bank_mask:0xf
    s_nop 1
    v_add_f32_dpp v21, v21, v21 row_mirror row_mask:0xf bank_mask:0xf
    v_mov_b32 v12, v21
    s_nop 1
    v_permlane16_swap_b32 v21, v12
    v_add_f32 v21, v21, v12
    v_mul_f32 v21, 0x3b124925, v21
    v_cvt_pk_bf16_f32 v20, v20, v20
    v_lshlrev_b32 v20, 16, v20
    v_cvt_pk_bf16_f32 v21, v21, v21
    v_lshlrev_b32 v21, 16, v21
    v_add_f32 v21, 0x3727c5ac, v21
    v_cvt_pk_bf16_f32 v21, v21, v21
    v_lshlrev_b32 v21, 16, v21
    v_sqrt_f32 v21, v21
    s_nop 0
    v_cvt_pk_bf16_f32 v21, v21, v21
    v_lshlrev_b32 v21, 16, v21
    v_rcp_f32 v21, v21
    v_readlane_b32 s56, v20, 0
    v_readlane_b32 s57, v20, 32
    v_readlane_b32 s58, v21, 0
    v_readlane_b32 s59, v21, 32
    v_cmp_eq_u32 vcc, 0, v164
    v_mov_b32 v20, s57
    v_mov_b32 v18, s56
    v_mov_b32 v21, s59
    v_mov_b32 v19, s58
    v_cndmask_b32 v20, v20, v18, vcc
    v_cndmask_b32 v21, v21, v19, vcc
    s_branch L_r2b6_20
L_r2h1_21:
    s_nop 7
    v_lshlrev_b32 v6, 4, v1
    ds_read_b128 v[32:35], v6 offset:43520
    ds_read_b128 v[36:39], v6 offset:44544
    ds_read_b128 v[40:43], v6 offset:45568
    ds_read_b128 v[44:47], v6 offset:46592
    ds_read_b128 v[48:51], v6 offset:47616
    ds_read_b128 v[52:55], v6 offset:48640
    ds_read_b128 v[56:59], v6 offset:49664
    ds_read_b128 v[60:63], v6 offset:50688
    s_waitcnt lgkmcnt(6)
    v_pk_add_f32 v[8:9], v[32:33], v[36:37]
    v_pk_add_f32 v[10:11], v[34:35], v[38:39]
    s_waitcnt lgkmcnt(5)
    v_pk_add_f32 v[8:9], v[8:9], v[40:41]
    v_pk_add_f32 v[10:11], v[10:11], v[42:43]
    s_waitcnt lgkmcnt(4)
    v_pk_add_f32 v[8:9], v[8:9], v[44:45]
    v_pk_add_f32 v[10:11], v[10:11], v[46:47]
    s_waitcnt lgkmcnt(3)
    v_pk_add_f32 v[8:9], v[8:9], v[48:49]
    v_pk_add_f32 v[10:11], v[10:11], v[50:51]
    s_waitcnt lgkmcnt(2)
    v_pk_add_f32 v[8:9], v[8:9], v[52:53]
    v_pk_add_f32 v[10:11], v[10:11], v[54:55]
    s_waitcnt lgkmcnt(1)
    v_pk_add_f32 v[8:9], v[8:9], v[56:57]
    v_pk_add_f32 v[10:11], v[10:11], v[58:59]
    s_waitcnt lgkmcnt(0)
    v_pk_add_f32 v[8:9], v[8:9], v[60:61]
    v_pk_add_f32 v[10:11], v[10:11], v[62:63]
    v_mov_b32 v12, v8
    v_mov_b32 v13, v9
    v_mov_b32 v14, v10
    v_mov_b32 v15, v11
    v_permlane32_swap_b32 v8, v12
    v_permlane32_swap_b32 v9, v13
    v_permlane32_swap_b32 v10, v14
    v_permlane32_swap_b32 v11, v15
    v_add_f32 v8, v8, v12
    v_add_f32 v9, v9, v13
    v_add_f32 v10, v10, v14
    v_add_f32 v11, v11, v15
    ds_write_b128 v6, v[8:11] offset:51712
L_r2b6_20:
    s_nop 7
    s_waitcnt lgkmcnt(0)
    s_barrier
    s_cmp_lg_u32 s62, 0
    s_cbranch_scc1 L_r2b7_22
    ds_read_b128 v[64:67], v6 offset:51712
    v_lshlrev_b32 v6, 4, v1
    ds_read_b128 v[32:35], v6 offset:10240
    ds_read_b128 v[36:39], v6 offset:11264
    ds_read_b128 v[40:43], v6 offset:12288
    ds_read_b128 v[44:47], v6 offset:13312
    ds_read_b128 v[48:51], v6 offset:14336
    ds_read_b128 v[52:55], v6 offset:15360
    ds_read_b128 v[56:59], v6 offset:16384
    ds_read_b128 v[60:63], v6 offset:17408
    s_waitcnt lgkmcnt(6)
    v_pk_add_f32 v[8:9], v[32:33], v[36:37]
    v_pk_add_f32 v[10:11], v[34:35], v[38:39]
    s_waitcnt lgkmcnt(5)
    v_pk_add_f32 v[8:9], v[8:9], v[40:41]
    v_pk_add_f32 v[10:11], v[10:11], v[42:43]
    s_waitcnt lgkmcnt(4)
    v_pk_add_f32 v[8:9], v[8:9], v[44:45]
    v_pk_add_f32 v[10:11], v[10:11], v[46:47]
    s_waitcnt lgkmcnt(3)
    v_pk_add_f32 v[8:9], v[8:9], v[48:49]
    v_pk_add_f32 v[10:11], v[10:11], v[50:51]
    s_waitcnt lgkmcnt(2)
    v_pk_add_f32 v[8:9], v[8:9], v[52:53]
    v_pk_add_f32 v[10:11], v[10:11], v[54:55]
    s_waitcnt lgkmcnt(1)
    v_pk_add_f32 v[8:9], v[8:9], v[56:57]
    v_pk_add_f32 v[10:11], v[10:11], v[58:59]
    s_waitcnt lgkmcnt(0)
    v_pk_add_f32 v[8:9], v[8:9], v[60:61]
    v_pk_add_f32 v[10:11], v[10:11], v[62:63]
    v_mov_b32 v12, v8
    v_mov_b32 v13, v9
    v_mov_b32 v14, v10
    v_mov_b32 v15, v11
    v_permlane32_swap_b32 v8, v12
    v_permlane32_swap_b32 v9, v13
    v_permlane32_swap_b32 v10, v14
    v_permlane32_swap_b32 v11, v15
    v_add_f32 v8, v8, v12
    v_add_f32 v9, v9, v13
    v_add_f32 v10, v10, v14
    v_add_f32 v11, v11, v15
    v_fma_f32 v8, -v20, v64, v8
    v_mul_f32 v8, v8, v21
    v_fma_f32 v9, -v20, v65, v9
    v_mul_f32 v9, v9, v21
    v_fma_f32 v10, -v20, v66, v10
    v_mul_f32 v10, v10, v21
    v_fma_f32 v11, -v20, v67, v11
    v_mul_f32 v11, v11, v21
    v_and_b32 v7, 1, v163
    v_lshlrev_b32 v7, 7, v7
    v_lshl_add_u32 v7, v164, 8, v7
    v_lshl_add_u32 v7, v165, 2, v7
    v_cvt_pk_bf16_f32 v8, v8, v8
    v_lshlrev_b32 v8, 16, v8
    v_mul_f32 v12, 0xbfb8aa3b, v8
    v_exp_f32 v12, v12
    s_nop 0
    v_add_f32 v12, 1.0, v12
    v_rcp_f32 v12, v12
    s_nop 0
    v_mul_f32 v8, v8, v12
    v_cvt_pk_bf16_f32 v8, v8, v8
    ds_write_b32 v7, v8 offset:1280
    v_cvt_pk_bf16_f32 v9, v9, v9
    v_lshlrev_b32 v9, 16, v9
    v_mul_f32 v13, 0xbfb8aa3b, v9
    v_exp_f32 v13, v13
    s_nop 0
    v_add_f32 v13, 1.0, v13
    v_rcp_f32 v13, v13
    s_nop 0
    v_mul_f32 v9, v9, v13
    v_cvt_pk_bf16_f32 v9, v9, v9
    ds_write_b32 v7, v9 offset:1312
    v_cvt_pk_bf16_f32 v10, v10, v10
    v_lshlrev_b32 v10, 16, v10
    v_mul_f32 v14, 0xbfb8aa3b, v10
    v_exp_f32 v14, v14
    s_nop 0
    v_add_f32 v14, 1.0, v14
    v_rcp_f32 v14, v14
    s_nop 0
    v_mul_f32 v10, v10, v14
    v_cvt_pk_bf16_f32 v10, v10, v10
    ds_write_b32 v7, v10 offset:1344
    v_cvt_pk_bf16_f32 v11, v11, v11
    v_lshlrev_b32 v11, 16, v11
    v_mul_f32 v15, 0xbfb8aa3b, v11
    v_exp_f32 v15, v15
    s_nop 0
    v_add_f32 v15, 1.0, v15
    v_rcp_f32 v15, v15
    s_nop 0
    v_mul_f32 v11, v11, v15
    v_cvt_pk_bf16_f32 v11, v11, v11
    ds_write_b32 v7, v11 offset:1376
L_r2b7_22:
    s_nop 7
    s_waitcnt lgkmcnt(0)
    s_barrier
    s_lshl_b32 s56, s62, 10
    v_add_u32 v7, s56, v6
    s_mul_i32 s57, s42, 3584
    s_add_u32 s56, s56, s57
    s_barrier
    ds_read_b128 v[8:11], v7 offset:34816
    ds_read_b128 v[12:15], v7 offset:39424
    s_waitcnt lgkmcnt(0)
    v_pk_add_f32 v[8:9], v[8:9], v[12:13]
    v_pk_add_f32 v[10:11], v[10:11], v[14:15]
    v_and_b32 v8, -2, v8
    v_and_b32 v9, -2, v9
    v_and_b32 v10, -2, v10
    v_and_b32 v11, -2, v11
    s_add_u32 s59, s56, 1114112
    buffer_store_dwordx4 v[8:11], v158, s[32:35], s59 offen offset:0 sc1
    s_endpgm
L_h_role3:
    s_nop 7
    s_cmp_lg_u32 s62, 0
    s_cbranch_scc1 L_h_end
    v_lshrrev_b32 v12, 3, v1
    v_mul_u32_u24 v7, 3584, v12
    v_lshl_add_u32 v7, v165, 4, v7
    v_mov_b32 v13, 0x7f000000
    v_cmp_gt_u32 vcc, 32, v1
    s_nop 1
    v_cndmask_b32 v14, v13, v7, vcc
    v_lshlrev_b32 v15, 4, v165
    s_lshl_b32 s56, s42, 7
    v_cmp_gt_u32 vcc, 8, v1
    v_lshlrev_b32 v16, 1, v165
    s_nop 0
    v_cndmask_b32 v16, v13, v16, vcc
    s_and_b32 s57, s42, 1
    s_mul_i32 s57, s57, 896
    s_bfe_u32 s58, s42, 0x20001
    s_lshl_b32 s58, s58, 6
    s_add_u32 s57, s57, s58
    s_lshr_b32 s58, s42, 3
    s_lshl_b32 s58, s58, 8
    s_add_u32 s57, s57, s58
    s_mov_b32 s60, 0
L_poll_23:
    s_nop 1
    s_add_u32 s59, s56, 1114112
    buffer_load_dwordx4 v[32:35], v7, s[32:35], s59 offen offset:0 sc1
    s_add_u32 s59, s56, 1142784
    buffer_load_dwordx4 v[36:39], v7, s[32:35], s59 offen offset:0 sc1
    s_add_u32 s59, s56, 1171456
    buffer_load_dwordx4 v[40:43], v7, s[32:35], s59 offen offset:0 sc1
    s_add_u32 s59, s56, 1200128
    buffer_load_dwordx4 v[44:47], v14, s[32:35], s59 offen offset:0 sc1
    s_add_u32 s59, s56, 1212416
    buffer_load_dwordx4 v[48:51], v15, s[32:35], s59 offen offset:2048 sc1
    s_waitcnt vmcnt(0)
    v_pk_add_f32 v[8:9], v[32:33], v[36:37]
    v_pk_add_f32 v[10:11], v[34:35], v[38:39]
    v_pk_add_f32 v[20:21], v[40:41], v[44:45]
    v_pk_add_f32 v[22:23], v[42:43], v[46:47]
    v_pk_add_f32 v[8:9], v[8:9], v[20:21]
    v_pk_add_f32 v[10:11], v[10:11], v[22:23]
    v_or_b32 v12, v32, v33
    v_or3_b32 v12, v12, v34, v35
    v_or3_b32 v12, v12, v36, v37
    v_or3_b32 v12, v12, v38, v39
    v_or3_b32 v12, v12, v40, v41
    v_or3_b32 v12, v12, v42, v43
    v_or3_b32 v12, v12, v44, v45
    v_or3_b32 v12, v12, v46, v47
    v_or3_b32 v12, v12, v48, v49
    v_or3_b32 v12, v12, v50, v51
    v_and_b32 v12, 1, v12
    v_cmp_ne_u32 vcc, 0, v12
    s_cbranch_vccz L_ok_24
    s_add_u32 s60, s60, 1
    s_cmp_lt_u32 s60, 200000
    s_cbranch_scc1 L_poll_23
L_ok_24:
    s_nop 1
    v_add_f32_dpp v8, v8, v8 row_ror:8 row_mask:0xf bank_mask:0xf
    v_add_f32_dpp v9, v9, v9 row_ror:8 row_mask:0xf bank_mask:0xf
    v_add_f32_dpp v10, v10, v10 row_ror:8 row_mask:0xf bank_mask:0xf
    v_add_f32_dpp v11, v11, v11 row_ror:8 row_mask:0xf bank_mask:0xf
    v_mov_b32 v20, v8
    s_nop 1
    v_permlane16_swap_b32 v8, v20
    v_add_f32 v8, v8, v20
    v_mov_b32 v21, v9
    s_nop 1
    v_permlane16_swap_b32 v9, v21
    v_add_f32 v9, v9, v21
    v_mov_b32 v22, v10
    s_nop 1
    v_permlane16_swap_b32 v10, v22
    v_add_f32 v10, v10, v22
    v_mov_b32 v23, v11
    s_nop 1
    v_permlane16_swap_b32 v11, v23
    v_add_f32 v11, v11, v23
    v_mov_b32 v20, v8
    s_nop 1
    v_permlane32_swap_b32 v8, v20
    v_add_f32 v8, v8, v20
    v_mov_b32 v21, v9
    s_nop 1
    v_permlane32_swap_b32 v9, v21
    v_add_f32 v9, v9, v21
    v_mov_b32 v22, v10
    s_nop 1
    v_permlane32_swap_b32 v10, v22
    v_add_f32 v10, v10, v22
    v_mov_b32 v23, v11
    s_nop 1
    v_permlane32_swap_b32 v11, v23
    v_add_f32 v11, v11, v23
    v_cvt_pk_bf16_f32 v8, v8, v8
    v_lshlrev_b32 v8, 16, v8
    v_add_f32 v8, v8, v48
    v_cvt_pk_bf16_f32 v8, v8, v8
    buffer_store_short v8, v16, s[36:39], s57 offen offset:0
    v_cvt_pk_bf16_f32 v9, v9, v9
    v_lshlrev_b32 v9, 16, v9
    v_add_f32 v9, v9, v49
    v_cvt_pk_bf16_f32 v9, v9, v9
    buffer_store_short v9, v16, s[36:39], s57 offen offset:16
    v_cvt_pk_bf16_f32 v10, v10, v10
    v_lshlrev_b32 v10, 16, v10
    v_add_f32 v10, v10, v50
    v_cvt_pk_bf16_f32 v10, v10, v10
    buffer_store_short v10, v16, s[36:39], s57 offen offset:32
    v_cvt_pk_bf16_f32 v11, v11, v11
    v_lshlrev_b32 v11, 16, v11
    v_add_f32 v11, v11, v51
    v_cvt_pk_bf16_f32 v11, v11, v11
    buffer_store_short v11, v16, s[36:39], s57 offen offset:48
    s_endpgm
L_end:
    s_endpgm
.section .rodata,"a"
.p2align 6
.amdhsa_kernel sequential_preLN__gqa_block_cached__dense_activation_silu__decode_kernel
  .amdhsa_next_free_vgpr 168
  .amdhsa_next_free_sgpr 102
  .amdhsa_accum_offset 168
  .amdhsa_group_segment_fixed_size 0
  .amdhsa_kernarg_size 88
  .amdhsa_user_sgpr_count 2
  .amdhsa_user_sgpr_kernarg_segment_ptr 1
  .amdhsa_system_sgpr_workgroup_id_x 1
.end_amdhsa_kernel
```
